```python
import torch

def _softmax(x, axis=-1):
    return torch.softmax(x, dim=axis)
def _gelu(x):
    return torch.nn.functional.gelu(x, approximate="tanh")
def _silu(x):
    return torch.nn.functional.silu(x)
def _sigmoid(x):
    return torch.sigmoid(x)
def _layernorm(x, axis=-1, eps=1e-5):
    m = x.mean(dim=axis, keepdim=True)
    v = x.var(dim=axis, keepdim=True, unbiased=False)
    return (x - m) / torch.sqrt(v + eps)
def _scatter_add(tgt, idx, src, axis=0):
    return tgt.clone().index_add_(axis, idx, src)
def _segment_sum(src, seg, n):
    out = torch.zeros((n,) + src.shape[1:], dtype=src.dtype)
    return out.index_add_(0, seg, src)
def _pad(x, pw):
    flat = tuple(v for pair in reversed(pw) for v in pair)
    return torch.nn.functional.pad(x, flat)

kernel_name = 'gated_mix__mha_block__glu_gated_glu__prompt'

def setup_inputs():

    _w = (lambda a: (lambda t: t.to(torch.bfloat16) if t.is_floating_point() else t)(torch.as_tensor(a)))
    def _A_setup():
        B, S, D, H = 1, 2048, 512, 32
        return {
            "x": _w((lambda *s: torch.randn(*s, dtype=torch.bfloat16) * 0.05)(B, S, D)),
            "wqkv": _w((lambda *s: torch.randn(*s, dtype=torch.bfloat16) * 0.8)(D, 3 * D)),
            "wo": _w((lambda *s: torch.randn(*s, dtype=torch.bfloat16) * 0.1)(D, D)),
        }
    _A_in = _A_setup()

    def _B_setup():
        B, S, D, F = 1, 2048, 512, 1376
        return {
            "x": _w((lambda *s: torch.randn(*s, dtype=torch.bfloat16) * 0.05)(B, S, D)),
            "w_gate": _w((lambda *s: torch.randn(*s, dtype=torch.bfloat16) * 0.8)(D, F)),
            "w_up": _w((lambda *s: torch.randn(*s, dtype=torch.bfloat16) * 0.05)(D, F)),
            "w_down": _w((lambda *s: torch.randn(*s, dtype=torch.bfloat16) * 0.05)(F, D)),
        }
    _B_in = _B_setup()

    return {
        "A_x": _A_in["x"],
        "A_wqkv": _A_in["wqkv"],
        "A_wo": _A_in["wo"],
        "B_x": _B_in["x"],
        "B_w_gate": _B_in["w_gate"],
        "B_w_up": _B_in["w_up"],
        "B_w_down": _B_in["w_down"],
        "gate_w": _w((lambda *s: torch.randn(*s, dtype=torch.bfloat16) * 0.05)(512) * 16.0),
    }

def reference(A_x, A_wqkv, A_wo, B_x, B_w_gate, B_w_up, B_w_down, gate_w):
    def _A_ref(x, wqkv, wo):
        B, S, D = x.shape
        H = 32
        Dh = D // H
        qkv = (lambda x, *d: x.permute(*d))((x @ wqkv).reshape(B, S, 3, H, Dh), 2, 0, 3, 1, 4)
        q, k, v = qkv[0], qkv[1], qkv[2]
        scores = torch.einsum("bhqd,bhkd->bhqk", q, k) * (Dh ** -0.5)
        p = _softmax(scores, axis=-1)
        o = torch.einsum("bhqk,bhkd->bhqd", p, v)
        return (lambda x, *d: x.permute(*d))(o, 0, 2, 1, 3).reshape(B, S, D) @ wo

    def _B_ref(x, w_gate, w_up, w_down):
        g = torch.einsum("bsd,df->bsf", x, w_gate)
        u = torch.einsum("bsd,df->bsf", x, w_up)
        h = _sigmoid(g) * u
        return torch.einsum("bsf,fd->bsd", h, w_down)

    x = A_x
    g = _sigmoid((x * gate_w).sum(-1, keepdims=True))
    a = _A_ref(x, A_wqkv, A_wo)
    b = _B_ref(x, B_w_gate, B_w_up, B_w_down)
    return g * a + (1 - g) * b
```

```asm
; @launch grid=(256,1,1) block=(768,1,1) lds=163840
.amdgcn_target "amdgcn-amd-amdhsa--gfx950"
.text
.globl gated_mix__mha_block__glu_gated_glu__prompt_kernel
.p2align 8
.type gated_mix__mha_block__glu_gated_glu__prompt_kernel,@function
gated_mix__mha_block__glu_gated_glu__prompt_kernel:
    s_cmp_ge_u32 s2, 256
    s_cbranch_scc1 L_exit
    s_load_dwordx16 s[4:19], s[0:1], 0
    s_load_dwordx4 s[20:23], s[0:1], 64
    s_load_dwordx2 s[24:25], s[0:1], 80
    v_lshrrev_b32 v1, 6, v0
    v_and_b32 v0, 63, v0
    s_and_b32 s3, s2, 7
    v_readfirstlane_b32 s26, v1
    s_lshr_b32 s69, s2, 3
    s_getpc_b64 s[46:47]
L_pc:
    s_sub_u32 s44, s69, 24
    s_mul_i32 s44, s44, 12
    s_add_u32 s44, s44, s26
    s_lshl_b32 s44, s44, 8
    s_min_u32 s44, s44, L_code_end-L_pc
    s_add_u32 s46, s46, s44
    s_addc_u32 s47, s47, 0
    v_lshlrev_b32 v1, 4, v0
    v_mov_b32 v2, 163584
    v_mov_b32 v3, 1
    s_cmp_lt_u32 s69, 24
    s_cbranch_scc1 L_nt
    v_lshlrev_b32 v5, 2, v0
    global_load_dword v167, v5, s[46:47]
L_nt:
    s_cmp_ge_u32 s26, 8
    s_cbranch_scc1 L_F
    s_cmp_ge_u32 s26, 4
    s_cbranch_scc1 L_help0
    s_cmp_ge_u32 s69, 24
    s_cbranch_scc1 L_pf
    s_and_b32 s44, s3, 3
    s_lshl_b32 s44, s44, 2
    s_and_b32 s45, s69, 3
    s_add_u32 s48, s44, s45
    s_lshr_b32 s49, s69, 2
    v_lshrrev_b32 v16, 3, v0
    v_and_b32 v5, 7, v0
    v_lshrrev_b32 v6, 1, v16
    v_xor_b32 v7, v5, v6
    v_lshlrev_b32 v7, 4, v7
    s_lshl_b32 s44, s48, 7
    s_lshl_b32 s45, s26, 5
    s_add_u32 s44, s44, s45
    v_add_u32 v13, s44, v16
    v_lshl_add_u32 v13, v13, 10, v7
    v_xor_b32 v14, 64, v13
    v_add_u32 v14, 8192, v14
    v_lshlrev_b32 v6, 2, v6
    v_and_b32 v6, 4, v6
    v_xor_b32 v5, v5, v6
    v_lshlrev_b32 v17, 4, v5
    s_lshl_b32 s56, s26, 12
    s_lshr_b32 s46, s26, 1
    s_and_b32 s47, s26, 1
    s_mul_i32 s44, s46, 8224
    s_lshl_b32 s45, s47, 12
    s_add_u32 s44, s44, s45
    s_add_u32 s57, s44, 16384
    s_mov_b32 s54, 0
    s_mov_b32 s55, 0
    s_mov_b32 s44, 0
    s_lshl_b32 s52, s44, 7
    s_lshl_b32 s44, s44, 1
    s_and_b32 s45, s26, 1
    s_add_u32 s44, s44, s45
    s_lshl_b32 s44, s44, 5
    s_mul_i32 s53, s44, 3072
    v_mul_u32_u24 v15, 3072, v16
    s_lshr_b32 s44, s3, 2
    s_mul_i32 s44, s44, 6
    s_add_u32 s44, s44, s49
    s_lshl_b32 s44, s44, 1
    s_add_u32 s44, s44, s46
    s_lshl_b32 s44, s44, 7
    v_add3_u32 v15, v15, v17, s44
    s_waitcnt lgkmcnt(0)
    s_mov_b32 s32, s4
    s_and_b32 s33, s5, 0xffff
    s_mov_b32 s34, 2097152
    s_mov_b32 s35, 0x20000
    s_mov_b32 s36, s6
    s_and_b32 s37, s7, 0xffff
    s_mov_b32 s38, 1572864
    s_mov_b32 s39, 0x20000
L_ld0:
    s_add_u32 m0, s54, s56
    s_add_u32 s44, s52, 16384
    buffer_load_dwordx4 v13, s[32:35], s52 offen lds
    s_add_u32 m0, m0, 1024
    s_add_u32 s55, s55, 1
    buffer_load_dwordx4 v14, s[32:35], s52 offen lds
    s_add_u32 m0, m0, 1024
    s_mov_b32 s45, s53
    buffer_load_dwordx4 v13, s[32:35], s44 offen lds
    s_add_u32 m0, m0, 1024
    s_add_u32 s52, s52, 128
    buffer_load_dwordx4 v14, s[32:35], s44 offen lds
    s_add_u32 m0, s54, s57
    s_nop 0
    buffer_load_dwordx4 v15, s[36:39], s45 offen lds
    s_add_u32 m0, m0, 1024
    s_add_u32 s45, s45, 24576
    buffer_load_dwordx4 v15, s[36:39], s45 offen lds
    s_add_u32 m0, m0, 1024
    s_add_u32 s45, s45, 24576
    buffer_load_dwordx4 v15, s[36:39], s45 offen lds
    s_add_u32 m0, m0, 1024
    s_add_u32 s45, s45, 24576
    buffer_load_dwordx4 v15, s[36:39], s45 offen lds
    s_add_u32 s53, s53, 196608
    s_and_b32 s52, s52, 1023
    s_cselect_b32 s46, 0, 1572864
    s_sub_u32 s53, s53, s46
    s_sub_u32 s54, s54, 33024
    s_cselect_b32 s54, 66048, s54
    s_cmp_lt_u32 s55, 2
    s_cbranch_scc1 L_ld0
    s_cmp_eq_u32 s55, 8
    s_cbranch_scc1 L_ld_end
    s_waitcnt vmcnt(8)
    s_barrier
    s_branch L_ld0
L_pf:
    v_lshrrev_b32 v4, 3, v0
    v_and_b32 v5, 7, v0
    v_lshlrev_b32 v5, 4, v5
    v_lshl_add_u32 v13, v4, 10, v5
    v_mov_b32 v6, 1024
    v_mov_b32 v7, 2560
    v_cmp_gt_u32 vcc, 32, v0
    s_sub_u32 s46, s69, 24
    s_lshl_b32 s46, s46, 2
    s_add_u32 s46, s46, s26
    v_cndmask_b32 v6, v7, v6, vcc
    v_add_u32 v14, v6, v1
    s_and_b32 s44, s3, 3
    s_lshl_b32 s44, s44, 5
    s_add_u32 s44, s44, s46
    s_lshl_b32 s52, s44, 14
    s_add_u32 s52, s52, 256
    s_lshr_b32 s44, s3, 2
    s_mul_i32 s44, s44, 1536
    s_mul_i32 s53, s46, 6144
    s_add_u32 s53, s53, s44
    s_add_u32 s53, s53, 393216
    s_mov_b32 s55, 2
    s_waitcnt lgkmcnt(0)
    s_mov_b32 s32, s4
    s_and_b32 s33, s5, 0xffff
    s_mov_b32 s34, 2097152
    s_mov_b32 s35, 0x20000
    s_mov_b32 s36, s6
    s_and_b32 s37, s7, 0xffff
    s_mov_b32 s38, 1572864
    s_mov_b32 s39, 0x20000
L_pf1:
    s_add_u32 s44, s52, 8192
    buffer_load_dwordx4 v[44:47], v13, s[32:35], s52 offen
    buffer_load_dwordx4 v[44:47], v13, s[32:35], s44 offen
    buffer_load_dwordx4 v[44:47], v1, s[36:39], s53 offen
    buffer_load_dwordx4 v[44:47], v14, s[36:39], s53 offen
    buffer_load_dwordx4 v[44:47], v1, s[36:39], s53 offen offset:3584
    s_add_u32 s52, s52, 128
    s_add_u32 s53, s53, 196608
    s_add_u32 s55, s55, 1
    s_cmp_lt_u32 s55, 8
    s_cbranch_scc1 L_pf1
    s_mov_b32 s36, s12
    s_and_b32 s37, s13, 0xffff
    s_mov_b32 s38, 1409024
    s_mov_b32 s39, 0x20000
    s_mov_b32 s40, s14
    s_and_b32 s41, s15, 0xffff
    s_mov_b32 s42, 1409024
    s_mov_b32 s43, 0x20000
    s_lshr_b32 s44, s3, 2
    s_mul_i32 s44, s44, 43
    s_and_b32 s45, s3, 1
    s_mul_i32 s45, s45, 24
    s_add_u32 s44, s44, s45
    s_lshl_b32 s44, s44, 5
    s_mul_i32 s53, s46, 2752
    s_add_u32 s53, s53, s44
    s_and_b32 s44, s3, 3
    s_xor_b32 s44, s44, 1
    s_lshl_b32 s44, s44, 5
    s_add_u32 s44, s44, s46
    s_lshl_b32 s52, s44, 14
    s_mov_b32 s55, 0
L_pf2:
    s_mov_b32 exec_hi, 0x3ffff
    buffer_load_dwordx4 v[44:47], v1, s[36:39], s53 offen
    buffer_load_dwordx4 v[44:47], v1, s[40:43], s53 offen
    s_mov_b32 exec_hi, -1
    buffer_load_dwordx4 v[44:47], v13, s[32:35], s52 offen
    s_add_u32 s53, s53, 88064
    s_add_u32 s55, s55, 1
    s_bitcmp1_b32 s55, 0
    s_mov_b32 s44, 4294959232
    s_cselect_b32 s44, 8192, s44
    s_add_u32 s52, s52, s44
    s_cmp_lt_u32 s55, 4
    s_cbranch_scc1 L_pf2
L_pf3:
    s_barrier
    s_barrier
    s_barrier
    s_barrier
    s_barrier
    s_barrier
L_ld_end:
    s_mov_b32 s28, s24
    s_and_b32 s29, s25, 0xffff
    s_mov_b32 s30, 33554432
    s_mov_b32 s31, 0x20000
    s_waitcnt vmcnt(8)
    s_barrier
    s_waitcnt vmcnt(0)
    s_branch L_b7
L_help0:
    v_lshl_add_u32 v5, v0, 2, v2
    v_mov_b32 v4, 0
    ds_write_b32 v5, v4
    s_waitcnt lgkmcnt(0)
    s_mov_b32 s28, s24
    s_and_b32 s29, s25, 0xffff
    s_mov_b32 s30, 33554432
    s_mov_b32 s31, 0x20000
    s_mov_b32 s40, s22
    s_and_b32 s41, s23, 0xffff
    s_mov_b32 s42, 256
    s_mov_b32 s43, 0x20000
    s_cmp_eq_u32 s26, 4
    s_cbranch_scc0 L_help2
    s_cmp_eq_u32 s69, 31
    s_cbranch_scc0 L_help2
    s_setprio 3
    s_add_u32 s46, s24, 14811136
    s_addc_u32 s47, s25, 0
    s_load_dword s45, s[46:47], 0 glc
    v_mov_b32 v44, 0
    v_mov_b32 v45, 0
    v_mov_b32 v46, 0
    v_mov_b32 v47, 0
    s_lshl_b32 s46, s3, 12
    s_add_u32 s46, s46, 14745600
    buffer_store_dwordx4 v[44:47], v1, s[28:31], s46 offen offset:0 sc1
    buffer_store_dwordx4 v[44:47], v1, s[28:31], s46 offen offset:1024 sc1
    buffer_store_dwordx4 v[44:47], v1, s[28:31], s46 offen offset:2048 sc1
    buffer_store_dwordx4 v[44:47], v1, s[28:31], s46 offen offset:3072 sc1
    s_waitcnt lgkmcnt(0)
    s_mul_i32 s45, s45, 0x19660d
    s_add_u32 s45, s45, 0x3c6ef35f
    s_max_u32 s45, s45, 1
    v_mov_b32 v6, s45
    s_lshl_b32 s46, s3, 2
    s_waitcnt vmcnt(0)
    s_mov_b64 exec, 1
    buffer_store_dword v6, off, s[40:43], s46 sc1
    s_mov_b64 exec, -1
    s_setprio 0
L_help2:
L_help3:
L_help4:
    s_barrier
    v_and_b32 v5, 7, v0
    v_lshlrev_b32 v5, 2, v5
    s_sub_u32 s48, s26, 4
    v_lshrrev_b32 v60, 3, v0
    v_and_b32 v61, 7, v0
    v_lshrrev_b32 v62, 1, v60
    s_and_b32 s44, s3, 2
    s_lshl_b32 s44, s44, 2
    s_and_b32 s45, s69, 7
    s_add_u32 s49, s44, s45
    s_lshr_b32 s44, s3, 2
    s_mul_i32 s44, s44, 43
    s_and_b32 s45, s3, 1
    s_mul_i32 s45, s45, 24
    s_add_u32 s51, s44, s45
    s_and_b32 s44, s3, 1
    s_sub_u32 s50, 6, s44
    s_lshr_b32 s45, s69, 3
    s_mul_i32 s47, s45, s50
    s_add_u32 s51, s51, s47
    s_cmp_eq_u32 s45, 3
    s_barrier
    s_cselect_b32 s44, s44, 0
    s_sub_u32 s50, s50, s44
    s_and_b32 s46, s48, 1
    s_lshl_b32 s45, s46, 2
    v_or_b32 v62, s45, v62
    v_xor_b32 v61, v61, v62
    v_lshlrev_b32 v61, 4, v61
    s_lshl_b32 s44, s49, 7
    s_lshl_b32 s45, s48, 3
    s_add_u32 s44, s44, s45
    v_add_u32 v60, s44, v60
    v_lshl_add_u32 v64, v60, 10, v61
    s_movk_i32 s44, 5462
    s_movk_i32 s47, 2752
    s_lshl_b32 s45, s46, 5
    v_add_u32 v60, 0, v0
    v_mul_u32_u24 v61, s44, v60
    v_lshrrev_b32 v61, 16, v61
    v_mul_u32_u24 v62, 12, v61
    v_sub_u32 v62, v60, v62
    v_lshrrev_b32 v60, 1, v62
    s_barrier
    v_cmp_gt_u32 vcc, s50, v60
    v_lshlrev_b32 v62, 4, v62
    v_add_u32 v61, s45, v61
    v_mad_u32_u24 v65, v61, s47, v62
    v_bfrev_b32 v60, 2
    v_cndmask_b32 v65, v60, v65, vcc
    v_add_u32 v60, 64, v0
    v_mul_u32_u24 v61, s44, v60
    v_lshrrev_b32 v61, 16, v61
    v_mul_u32_u24 v62, 12, v61
    v_sub_u32 v62, v60, v62
    v_lshrrev_b32 v60, 1, v62
    v_cmp_gt_u32 vcc, s50, v60
    v_lshlrev_b32 v62, 4, v62
    v_add_u32 v61, s45, v61
    v_mad_u32_u24 v66, v61, s47, v62
    v_bfrev_b32 v60, 2
    v_cndmask_b32 v66, v60, v66, vcc
    v_add_u32 v60, 128, v0
    v_mul_u32_u24 v61, s44, v60
    v_lshrrev_b32 v61, 16, v61
    s_barrier
    v_mul_u32_u24 v62, 12, v61
    v_sub_u32 v62, v60, v62
    v_lshrrev_b32 v60, 1, v62
    v_cmp_gt_u32 vcc, s50, v60
    v_lshlrev_b32 v62, 4, v62
    v_add_u32 v61, s45, v61
    v_mad_u32_u24 v67, v61, s47, v62
    v_bfrev_b32 v60, 2
    v_cndmask_b32 v67, v60, v67, vcc
    s_lshl_b32 s60, s48, 10
    s_add_u32 s60, s60, 49152
    s_mul_i32 s45, s46, 6144
    s_lshr_b32 s46, s48, 1
    s_mul_i32 s47, s46, 12320
    s_add_u32 s45, s45, s47
    s_add_u32 s61, s45, 81920
    s_mov_b32 s44, 0
    s_lshl_b32 s62, s44, 7
    s_mul_i32 s63, s44, 176128
    s_barrier
    s_cmp_eq_u32 s26, 4
    s_cbranch_scc0 L_help5
    buffer_load_dword v4, v5, s[40:43], 0 offen sc1
L_help5:
    s_mov_b32 s32, s4
    s_and_b32 s33, s5, 0xffff
    s_mov_b32 s34, 2097152
    s_mov_b32 s35, 0x20000
    s_cmp_lt_u32 s48, 2
    s_cselect_b32 s46, s12, s14
    s_cselect_b32 s47, s13, s15
    s_lshl_b32 s44, s51, 5
    s_add_u32 s36, s46, s44
    s_addc_u32 s37, s47, 0
    s_and_b32 s37, s37, 0xffff
    s_sub_u32 s38, 1409024, s44
    s_mov_b32 s39, 0x20000
    s_add_u32 s61, s61, 24832
    s_barrier
    s_mov_b32 m0, s61
    s_add_u32 s46, s63, 44032
    buffer_load_dwordx4 v65, s[36:39], s63 offen lds
    s_add_u32 m0, m0, 1024
    s_nop 0
    buffer_load_dwordx4 v66, s[36:39], s63 offen lds
    s_add_u32 m0, m0, 1024
    s_nop 0
    buffer_load_dwordx4 v67, s[36:39], s63 offen lds
    s_add_u32 m0, m0, 1024
    s_nop 0
    buffer_load_dwordx4 v65, s[36:39], s46 offen lds
    s_add_u32 m0, m0, 1024
    s_nop 0
    buffer_load_dwordx4 v66, s[36:39], s46 offen lds
    s_add_u32 m0, m0, 1024
    s_nop 0
    buffer_load_dwordx4 v67, s[36:39], s46 offen lds
    s_add_u32 s61, s61, 24832
    s_add_u32 s63, s63, 176128
    s_barrier
    s_mov_b32 m0, s60
    s_mov_b32 s46, s62
    buffer_load_dwordx4 v64, s[32:35], s46 offen lds
    s_add_u32 m0, m0, 4096
    s_add_u32 s46, s46, 32768
    buffer_load_dwordx4 v64, s[32:35], s46 offen lds
    s_add_u32 m0, m0, 4096
    s_add_u32 s46, s46, 32768
    buffer_load_dwordx4 v64, s[32:35], s46 offen lds
    s_add_u32 m0, m0, 4096
    s_add_u32 s46, s46, 32768
    buffer_load_dwordx4 v64, s[32:35], s46 offen lds
    s_barrier
    s_mov_b32 m0, s61
    s_add_u32 s46, s63, 44032
    buffer_load_dwordx4 v65, s[36:39], s63 offen lds
    s_add_u32 m0, m0, 1024
    s_nop 0
    buffer_load_dwordx4 v66, s[36:39], s63 offen lds
    s_add_u32 m0, m0, 1024
    s_nop 0
    buffer_load_dwordx4 v67, s[36:39], s63 offen lds
    s_add_u32 m0, m0, 1024
    s_nop 0
    buffer_load_dwordx4 v65, s[36:39], s46 offen lds
    s_add_u32 m0, m0, 1024
    s_nop 0
    buffer_load_dwordx4 v66, s[36:39], s46 offen lds
    s_add_u32 m0, m0, 1024
    s_nop 0
    buffer_load_dwordx4 v67, s[36:39], s46 offen lds
    s_waitcnt vmcnt(6)
    s_mov_b64 exec, 1
    ds_add_u32 v2, v3 offset:40
    s_mov_b64 exec, -1
    s_cmp_eq_u32 s26, 4
    s_cbranch_scc0 L_pre
    s_mov_b32 s68, 0
L_np:
    s_waitcnt vmcnt(0)
    v_cmp_eq_u32 vcc, 0, v4
    s_cmp_gt_u32 s68, 200000
    s_cbranch_scc1 L_ng
    s_cbranch_vccz L_ng
    s_add_u32 s68, s68, 1
    s_sleep 4
    buffer_load_dword v4, v5, s[40:43], 0 offen sc1
    s_branch L_np
L_ng:
    s_mov_b64 exec, 1
    ds_write_b32 v2, v4 offset:0
    s_cmp_eq_u32 s2, 255
    s_cbranch_scc0 L_nw
    s_mov_b32 s44, 14811136
    buffer_store_dword v4, off, s[28:31], s44 sc1
L_nw:
    s_mov_b64 exec, -1
L_pre:
    s_add_u32 s60, s60, 16384
    s_add_u32 s62, s62, 128
    s_sub_u32 s61, s61, 49664
    s_add_u32 s63, s63, 176128
    s_mov_b32 s68, 0
L_pre_spin:
    ds_read_b32 v6, v2 offset:36
    s_add_u32 s68, s68, 1
    s_waitcnt lgkmcnt(0)
    v_cmp_gt_u32 vcc, 4, v6
    s_cmp_gt_u32 s68, 2000000
    s_cbranch_scc1 L_pre_ok
    s_cbranch_vccz L_pre_ok
    s_sleep 1
    s_branch L_pre_spin
L_pre_ok:
    s_mov_b32 m0, s60
    s_mov_b32 s46, s62
    buffer_load_dwordx4 v64, s[32:35], s46 offen lds
    s_add_u32 m0, m0, 4096
    s_add_u32 s46, s46, 32768
    buffer_load_dwordx4 v64, s[32:35], s46 offen lds
    s_add_u32 m0, m0, 4096
    s_add_u32 s46, s46, 32768
    buffer_load_dwordx4 v64, s[32:35], s46 offen lds
    s_add_u32 m0, m0, 4096
    s_add_u32 s46, s46, 32768
    buffer_load_dwordx4 v64, s[32:35], s46 offen lds
    s_waitcnt vmcnt(0)
    s_mov_b64 exec, 1
    ds_add_u32 v2, v3 offset:36
    s_mov_b64 exec, -1
    s_branch L_b7x
L_b7:
    s_barrier
    s_and_b32 s44, s3, 3
    s_lshl_b32 s44, s44, 6
    s_lshr_b32 s45, s3, 2
    s_lshl_b32 s45, s45, 5
    s_add_u32 s44, s44, s45
    s_add_u32 s44, s44, s69
    s_lshl_b32 s44, s44, 2
    s_add_u32 s44, s44, s26
    s_lshl_b32 s59, s44, 1
    s_lshl_b32 s44, s59, 10
    s_mov_b32 s36, s18
    s_and_b32 s37, s19, 0xffff
    s_mov_b32 s38, 1024
    s_mov_b32 s39, 0x20000
    buffer_load_dwordx4 v[44:47], v1, s[36:39], 0 offen
    buffer_load_dwordx4 v[48:51], v1, s[32:35], s44 offen
    buffer_load_dwordx4 v[52:55], v1, s[32:35], s44 offen offset:1024
    s_waitcnt vmcnt(0)
    v_mov_b32 v6, 0
    v_mov_b32 v7, 0
    v_dot2c_f32_bf16 v6, v48, v44
    v_dot2c_f32_bf16 v7, v52, v44
    v_dot2c_f32_bf16 v6, v49, v45
    v_dot2c_f32_bf16 v7, v53, v45
    v_dot2c_f32_bf16 v6, v50, v46
    v_dot2c_f32_bf16 v7, v54, v46
    v_dot2c_f32_bf16 v6, v51, v47
    v_dot2c_f32_bf16 v7, v55, v47
    s_nop 2
    s_nop 0
    v_add_f32_dpp v6, v6, v6 row_shr:1
    v_add_f32_dpp v7, v7, v7 row_shr:1
    s_nop 0
    v_add_f32_dpp v6, v6, v6 row_shr:2
    v_add_f32_dpp v7, v7, v7 row_shr:2
    s_nop 0
    v_add_f32_dpp v6, v6, v6 row_shr:4
    v_add_f32_dpp v7, v7, v7 row_shr:4
    s_nop 0
    v_add_f32_dpp v6, v6, v6 row_shr:8
    v_add_f32_dpp v7, v7, v7 row_shr:8
    s_nop 0
    v_add_f32_dpp v6, v6, v6 row_bcast:15 row_mask:0xa
    v_add_f32_dpp v7, v7, v7 row_bcast:15 row_mask:0xa
    s_nop 0
    v_add_f32_dpp v6, v6, v6 row_bcast:31 row_mask:0xc
    v_add_f32_dpp v7, v7, v7 row_bcast:31 row_mask:0xc
    v_mul_f32 v6, 0xbfb8aa3b, v6
    v_mul_f32 v7, 0xbfb8aa3b, v7
    v_exp_f32 v6, v6
    v_exp_f32 v7, v7
    s_nop 0
    v_add_f32 v6, 1.0, v6
    v_add_f32 v7, 1.0, v7
    v_rcp_f32 v16, v6
    v_rcp_f32 v18, v7
L_b7x:
    s_lshl_b32 s44, s3, 2
    s_and_b32 s45, s69, 3
    s_add_u32 s48, s44, s45
    s_lshr_b32 s44, s69, 2
    s_lshl_b32 s44, s44, 3
    s_and_b32 s45, s26, 3
    s_lshl_b32 s45, s45, 1
    s_add_u32 s44, s44, s45
    s_lshr_b32 s46, s26, 2
    s_add_u32 s49, s44, s46
    s_lshl_b32 s44, s48, 16
    s_lshl_b32 s53, s26, 10
    s_add_u32 s51, s44, s53
    s_add_u32 s52, s51, 4194304
    s_add_u32 s51, s51, 2097152
    s_lshl_b32 s45, s49, 10
    s_add_u32 s55, s44, s45
    s_xor_b32 s56, s55, 1024
    s_lshl_b32 s46, s46, 12
    v_and_b32 v77, 51, v0
    v_bfe_u32 v6, v0, 2, 1
    v_lshl_or_b32 v77, v6, 3, v77
    v_bfe_u32 v6, v0, 3, 1
    v_lshl_or_b32 v77, v6, 2, v77
    v_lshlrev_b32 v77, 4, v77
    v_add_u32 v8, s46, v77
    v_mov_b32 v76, 0xdddddddd
    v_and_b32 v6, 15, v0
    v_lshlrev_b32 v6, 4, v6
    v_lshrrev_b32 v7, 5, v0
    v_lshl_add_u32 v7, v7, 8, v6
    s_add_u32 s46, s46, 8192
    v_add_u32 v9, s46, v7
    v_and_b32 v7, 16, v0
    v_cmp_ne_u32 vcc, 0, v7
    v_add_u32 v6, 156672, v6
    v_mov_b32 v11, 1
    s_nop 0
    v_cndmask_b32 v9, v9, v6, vcc
    v_cndmask_b32 v11, v11, 0, vcc
    s_lshl_b32 s44, s26, 9
    v_add_u32 v10, s44, v6
    v_and_b32 v7, 27, v0
    v_cmp_eq_u32 vcc, 16, v7
    v_mov_b32 v6, 0x3f803f80
    s_mov_b32 s50, 0
    s_mov_b32 s54, 16
    v_cndmask_b32 v36, 0, v6, vcc
    v_cndmask_b32 v37, 0, v6, vcc
    v_cndmask_b32 v38, 0, v6, vcc
    v_cndmask_b32 v39, 0, v6, vcc
    s_mov_b32 exec_lo, 0xffff0000
    s_mov_b32 exec_hi, 0
    ds_write_b128 v10, v[36:39]
    s_mov_b64 exec, -1
    v_mov_b32 v40, 0
    v_mov_b32 v41, 0
    v_pk_mov_b32 v[80:81], v[40:41], v[40:41]
    v_pk_mov_b32 v[82:83], v[40:41], v[40:41]
    v_pk_mov_b32 v[84:85], v[40:41], v[40:41]
    v_pk_mov_b32 v[86:87], v[40:41], v[40:41]
    v_pk_mov_b32 v[88:89], v[40:41], v[40:41]
    v_pk_mov_b32 v[90:91], v[40:41], v[40:41]
    v_pk_mov_b32 v[92:93], v[40:41], v[40:41]
    v_pk_mov_b32 v[94:95], v[40:41], v[40:41]
    v_pk_mov_b32 v[96:97], v[40:41], v[40:41]
    v_pk_mov_b32 v[98:99], v[40:41], v[40:41]
    v_pk_mov_b32 v[100:101], v[40:41], v[40:41]
    v_pk_mov_b32 v[102:103], v[40:41], v[40:41]
    v_pk_mov_b32 v[104:105], v[40:41], v[40:41]
    v_pk_mov_b32 v[106:107], v[40:41], v[40:41]
    v_pk_mov_b32 v[108:109], v[40:41], v[40:41]
    v_pk_mov_b32 v[110:111], v[40:41], v[40:41]
    s_mov_b32 s57, 32768
    s_mov_b32 s60, 99
    s_cmp_lt_u32 s26, 4
    s_cbranch_scc0 L_at_nogst
    s_mov_b32 s68, 0
L_gtag_spin:
    ds_read_b32 v17, v2 offset:0
    s_add_u32 s68, s68, 1
    s_waitcnt lgkmcnt(0)
    v_cmp_gt_u32 vcc, 1, v17
    s_cmp_gt_u32 s68, 2000000
    s_cbranch_scc1 L_gtag_ok
    s_cbranch_vccz L_gtag_ok
    s_sleep 2
    s_branch L_gtag_spin
L_gtag_ok:
    v_mov_b32 v19, v17
    s_mov_b32 s60, 0
L_at_nogst:
    s_cmp_eq_u32 s26, 0
    s_cbranch_scc0 L_at_waitgo
    s_lshr_b32 s44, s3, 1
    s_lshl_b32 s44, s44, 1
    s_bfe_u32 s45, s69, 0x10001
    s_add_u32 s44, s44, s45
    s_lshl_b32 s44, s44, 10
    s_add_u32 s44, s44, 14745600
    v_min_u32 v15, 5, v0
    v_lshlrev_b32 v15, 7, v15
    s_mov_b32 s68, 0
L_atpost_spin:
    ds_read_b32 v4, v2 offset:32
    s_add_u32 s68, s68, 1
    s_waitcnt lgkmcnt(0)
    v_cmp_gt_u32 vcc, 4, v4
    s_cmp_gt_u32 s68, 2000000
    s_cbranch_scc1 L_atpost_ok
    s_cbranch_vccz L_atpost_ok
    s_sleep 1
    s_branch L_atpost_spin
L_atpost_ok:
    s_mov_b32 s68, 0
    s_mov_b64 exec, 63
    v_mov_b32 v4, 0
    buffer_atomic_or v4, v15, s[28:31], s44 offen sc0 sc1
L_atq_poll:
    s_add_u32 s68, s68, 1
    s_waitcnt vmcnt(0)
    v_cmp_gt_u32 vcc, 16, v4
    s_cmp_gt_u32 s68, 200000
    s_cbranch_scc1 L_atq_got
    s_cbranch_vccz L_atq_got
    s_sleep 2
    v_mov_b32 v4, 0
    buffer_atomic_or v4, v15, s[28:31], s44 offen sc0 sc1
    s_branch L_atq_poll
L_atq_got:
    s_mov_b64 exec, -1
    ds_write_b32 v2, v3 offset:12
    s_branch L_at_go
L_at_waitgo:
    s_mov_b32 s68, 0
L_atgo_spin:
    ds_read_b32 v4, v2 offset:12
    s_add_u32 s68, s68, 1
    s_waitcnt lgkmcnt(0)
    v_cmp_gt_u32 vcc, 1, v4
    s_cmp_gt_u32 s68, 2000000
    s_cbranch_scc1 L_atgo_ok
    s_cbranch_vccz L_atgo_ok
    s_sleep 1
    s_branch L_atgo_spin
L_atgo_ok:
L_at_go:
    buffer_load_dwordx4 v[20:23], v1, s[28:31], s55 offen sc1
    buffer_load_dwordx4 v[24:27], v1, s[28:31], s56 offen sc1
    s_add_u32 m0, s53, 0
    s_nop 0
    buffer_load_dwordx4 v1, s[28:31], s51 offen sc1 lds
    s_add_u32 m0, m0, 8192
    s_add_u32 s51, s51, 8192
    buffer_load_dwordx4 v1, s[28:31], s52 offen sc1 lds
    s_add_u32 s52, s52, 8192
    s_waitcnt vmcnt(0) lgkmcnt(0)
    s_mov_b64 exec, 1
    ds_add_u32 v2, v3 offset:4
    s_mov_b64 exec, -1
    s_add_u32 m0, s53, 16384
    s_nop 0
    buffer_load_dwordx4 v1, s[28:31], s51 offen sc1 lds
    s_add_u32 m0, m0, 8192
    s_add_u32 s51, s51, 8192
    buffer_load_dwordx4 v1, s[28:31], s52 offen sc1 lds
    s_add_u32 s52, s52, 8192
    s_mov_b32 s68, 0
L_at0_spin:
    ds_read_b32 v4, v2 offset:4
    s_add_u32 s68, s68, 1
    s_waitcnt lgkmcnt(0)
    v_cmp_gt_u32 vcc, 8, v4
    s_cmp_gt_u32 s68, 2000000
    s_cbranch_scc1 L_at0_ok
    s_cbranch_vccz L_at0_ok
    s_branch L_at0_spin
L_at0_ok:
    ds_read_b128 v[32:35], v1
    ds_read_b128 v[28:31], v8
    s_waitcnt lgkmcnt(1)
    v_mfma_f32_32x32x16_bf16 v[44:59], v[32:35], v[20:23], 0
    v_mfma_f32_32x32x16_bf16 v[60:75], v[32:35], v[24:27], 0
    ds_read_b128 v[32:35], v9
    s_nop 9
    v_max3_f32 v4, v44, v45, v46
    v_max3_f32 v4, v4, v47, v48
    v_max3_f32 v4, v4, v49, v50
    v_max3_f32 v4, v4, v51, v52
    v_max3_f32 v4, v4, v53, v54
    v_max3_f32 v4, v4, v55, v56
    v_max3_f32 v4, v4, v57, v58
    v_max_f32 v4, v4, v59
    v_mov_b32 v5, v4
    s_nop 1
    v_permlane32_swap_b32 v4, v5
    s_nop 1
    v_max_f32 v4, v4, v5
    v_sub_f32 v112, 0, v4
    v_sub_f32 v113, 0, v4
    v_pk_mov_b32 v[114:115], v[112:113], v[112:113]
    v_pk_mov_b32 v[116:117], v[112:113], v[112:113]
    v_pk_mov_b32 v[118:119], v[112:113], v[112:113]
    v_pk_mov_b32 v[120:121], v[112:113], v[112:113]
    v_pk_mov_b32 v[122:123], v[112:113], v[112:113]
    v_pk_mov_b32 v[124:125], v[112:113], v[112:113]
    v_pk_mov_b32 v[126:127], v[112:113], v[112:113]
    s_waitcnt lgkmcnt(0)
    s_nop 0
    v_max3_f32 v4, v60, v61, v62
    v_max3_f32 v4, v4, v63, v64
    v_max3_f32 v4, v4, v65, v66
    v_max3_f32 v4, v4, v67, v68
    v_max3_f32 v4, v4, v69, v70
    v_max3_f32 v4, v4, v71, v72
    v_max3_f32 v4, v4, v73, v74
    v_max_f32 v4, v4, v75
    v_mfma_f32_32x32x16_bf16 v[44:59], v[28:31], v[20:23], v[112:127]
    v_mov_b32 v5, v4
    s_nop 1
    v_permlane32_swap_b32 v4, v5
    s_nop 1
    v_max_f32 v4, v4, v5
    v_sub_f32 v128, 0, v4
    v_sub_f32 v129, 0, v4
    v_pk_mov_b32 v[130:131], v[128:129], v[128:129]
    v_pk_mov_b32 v[132:133], v[128:129], v[128:129]
    v_pk_mov_b32 v[134:135], v[128:129], v[128:129]
    v_pk_mov_b32 v[136:137], v[128:129], v[128:129]
    v_pk_mov_b32 v[138:139], v[128:129], v[128:129]
    v_pk_mov_b32 v[140:141], v[128:129], v[128:129]
    v_pk_mov_b32 v[142:143], v[128:129], v[128:129]
    v_pk_mov_b32 v[68:69], v[40:41], v[40:41]
    v_pk_mov_b32 v[70:71], v[40:41], v[40:41]
    v_pk_mov_b32 v[72:73], v[40:41], v[40:41]
    v_pk_mov_b32 v[74:75], v[40:41], v[40:41]
    s_cmp_lt_u32 s26, 4
    s_cbranch_scc1 L_at_np
    s_setprio 1
L_at_np:
.p2align 6
L_at_loop:
    s_bitcmp1_b32 0x24, s50
    s_mov_b32 s44, 4294934528
    s_cselect_b32 s58, s44, 16384
    s_cmp_ge_u32 s26, 4
    s_cbranch_scc1 L_pr_1
    s_setprio 1
L_pr_1:
    v_exp_f32 v44, v44
    v_exp_f32 v45, v45
    v_smfmac_f32_32x32x32_bf16 v[96:111], v[36:39], v[68:75], v76
    ds_read_b128 v[36:39], v9 offset:512
    v_exp_f32 v46, v46
    v_exp_f32 v47, v47
    v_exp_f32 v48, v48
    v_exp_f32 v49, v49
    v_mfma_f32_32x32x16_bf16 v[60:75], v[28:31], v[24:27], v[128:143]
    ds_read_b128 v[28:31], v8 offset:1024
    v_exp_f32 v50, v50
    v_exp_f32 v51, v51
    v_exp_f32 v52, v52
    v_exp_f32 v53, v53
    s_waitcnt lgkmcnt(2)
    v_smfmac_f32_32x32x32_bf16 v[80:95], v[32:35], v[44:51], v76
    v_exp_f32 v54, v54
    v_exp_f32 v55, v55
    v_exp_f32 v56, v56
    v_exp_f32 v57, v57
    v_exp_f32 v58, v58
    v_exp_f32 v59, v59
    v_exp_f32 v60, v60
    v_exp_f32 v61, v61
    s_waitcnt lgkmcnt(0)
    v_smfmac_f32_32x32x32_bf16 v[80:95], v[36:39], v[52:59], v76
    s_waitcnt vmcnt(0)
    s_mov_b64 exec, 1
    ds_add_u32 v2, v3 offset:4
    s_mov_b64 exec, -1
    v_exp_f32 v62, v62
    v_exp_f32 v63, v63
    v_exp_f32 v64, v64
    v_exp_f32 v65, v65
    v_mfma_f32_32x32x16_bf16 v[44:59], v[28:31], v[20:23], v[112:127]
    v_exp_f32 v66, v66
    v_exp_f32 v67, v67
    v_exp_f32 v68, v68
    v_exp_f32 v69, v69
    v_smfmac_f32_32x32x32_bf16 v[96:111], v[32:35], v[60:67], v76
    ds_read_b128 v[32:35], v9 offset:1024
    v_exp_f32 v70, v70
    v_exp_f32 v71, v71
    v_exp_f32 v72, v72
    v_exp_f32 v73, v73
    v_exp_f32 v74, v74
    v_exp_f32 v75, v75
    v_exp_f32 v44, v44
    v_exp_f32 v45, v45
    v_smfmac_f32_32x32x32_bf16 v[96:111], v[36:39], v[68:75], v76
    ds_read_b128 v[36:39], v9 offset:1536
    v_exp_f32 v46, v46
    v_exp_f32 v47, v47
    v_exp_f32 v48, v48
    v_exp_f32 v49, v49
    v_mfma_f32_32x32x16_bf16 v[60:75], v[28:31], v[24:27], v[128:143]
    ds_read_b128 v[28:31], v8 offset:2048
    v_exp_f32 v50, v50
    v_exp_f32 v51, v51
    v_exp_f32 v52, v52
    v_exp_f32 v53, v53
    s_waitcnt lgkmcnt(2)
    v_smfmac_f32_32x32x32_bf16 v[80:95], v[32:35], v[44:51], v76
    v_exp_f32 v54, v54
    v_exp_f32 v55, v55
    v_exp_f32 v56, v56
    v_exp_f32 v57, v57
    v_exp_f32 v58, v58
    v_exp_f32 v59, v59
    v_exp_f32 v60, v60
    v_exp_f32 v61, v61
    s_waitcnt lgkmcnt(0)
    v_smfmac_f32_32x32x32_bf16 v[80:95], v[36:39], v[52:59], v76
    v_exp_f32 v62, v62
    v_exp_f32 v63, v63
    v_exp_f32 v64, v64
    v_exp_f32 v65, v65
    v_mfma_f32_32x32x16_bf16 v[44:59], v[28:31], v[20:23], v[112:127]
    v_exp_f32 v66, v66
    v_exp_f32 v67, v67
    v_exp_f32 v68, v68
    v_exp_f32 v69, v69
    v_smfmac_f32_32x32x32_bf16 v[96:111], v[32:35], v[60:67], v76
    ds_read_b128 v[32:35], v9 offset:2048
    v_exp_f32 v70, v70
    v_exp_f32 v71, v71
    v_exp_f32 v72, v72
    v_exp_f32 v73, v73
    v_exp_f32 v74, v74
    v_exp_f32 v75, v75
    v_exp_f32 v44, v44
    v_exp_f32 v45, v45
    v_smfmac_f32_32x32x32_bf16 v[96:111], v[36:39], v[68:75], v76
    ds_read_b128 v[36:39], v9 offset:2560
    ds_read_b32 v10, v2 offset:4
    v_exp_f32 v46, v46
    v_exp_f32 v47, v47
    v_exp_f32 v48, v48
    v_exp_f32 v49, v49
    v_mfma_f32_32x32x16_bf16 v[60:75], v[28:31], v[24:27], v[128:143]
    ds_read_b128 v[28:31], v8 offset:3072
    v_exp_f32 v50, v50
    v_exp_f32 v51, v51
    v_exp_f32 v52, v52
    v_exp_f32 v53, v53
    s_waitcnt lgkmcnt(3)
    v_smfmac_f32_32x32x32_bf16 v[80:95], v[32:35], v[44:51], v76
    v_exp_f32 v54, v54
    v_exp_f32 v55, v55
    v_exp_f32 v56, v56
    v_exp_f32 v57, v57
    v_exp_f32 v58, v58
    v_exp_f32 v59, v59
    v_exp_f32 v60, v60
    v_exp_f32 v61, v61
    s_waitcnt lgkmcnt(0)
    v_smfmac_f32_32x32x32_bf16 v[80:95], v[36:39], v[52:59], v76
    v_exp_f32 v62, v62
    v_exp_f32 v63, v63
    v_exp_f32 v64, v64
    v_exp_f32 v65, v65
    v_mfma_f32_32x32x16_bf16 v[44:59], v[28:31], v[20:23], v[112:127]
    v_exp_f32 v66, v66
    v_exp_f32 v67, v67
    v_exp_f32 v68, v68
    v_exp_f32 v69, v69
    v_smfmac_f32_32x32x32_bf16 v[96:111], v[32:35], v[60:67], v76
    ds_read_b128 v[32:35], v9 offset:3072
    v_cmp_gt_u32 vcc, s54, v10
    s_cmp_lt_u32 s50, 6
    s_cbranch_vccnz L_at_slow
L_at_back:
    s_cbranch_scc0 L_at_dmadone
    s_add_u32 m0, s53, s57
    s_nop 0
    buffer_load_dwordx4 v1, s[28:31], s51 offen sc1 lds
    s_add_u32 m0, m0, 8192
    s_add_u32 s51, s51, 8192
    buffer_load_dwordx4 v1, s[28:31], s52 offen sc1 lds
    s_add_u32 s52, s52, 8192
    s_add_u32 s57, s57, 16384
    s_cmp_eq_u32 s57, 49152
    s_cselect_b32 s57, 0, s57
    s_cmp_eq_u32 s50, s60
    s_cbranch_scc1 L_at_gst
L_at_dmadone:
    v_exp_f32 v70, v70
    v_exp_f32 v71, v71
    v_exp_f32 v72, v72
    v_exp_f32 v73, v73
    v_exp_f32 v74, v74
    v_exp_f32 v75, v75
    s_cmp_ge_u32 s26, 4
    s_cbranch_scc1 L_pr_2
    s_setprio 0
L_pr_2:
    v_exp_f32 v44, v44
    v_exp_f32 v45, v45
    v_smfmac_f32_32x32x32_bf16 v[96:111], v[36:39], v[68:75], v76
    ds_read_b128 v[36:39], v9 offset:3584
    v_exp_f32 v46, v46
    v_exp_f32 v47, v47
    v_exp_f32 v48, v48
    v_exp_f32 v49, v49
    v_mfma_f32_32x32x16_bf16 v[60:75], v[28:31], v[24:27], v[128:143]
    v_add_u32 v8, s58, v8
    ds_read_b128 v[28:31], v8
    v_exp_f32 v50, v50
    v_exp_f32 v51, v51
    v_exp_f32 v52, v52
    v_exp_f32 v53, v53
    s_waitcnt lgkmcnt(2)
    v_smfmac_f32_32x32x32_bf16 v[80:95], v[32:35], v[44:51], v76
    v_exp_f32 v54, v54
    v_exp_f32 v55, v55
    v_exp_f32 v56, v56
    v_exp_f32 v57, v57
    v_exp_f32 v58, v58
    v_exp_f32 v59, v59
    v_exp_f32 v60, v60
    v_exp_f32 v61, v61
    s_waitcnt lgkmcnt(0)
    v_smfmac_f32_32x32x32_bf16 v[80:95], v[36:39], v[52:59], v76
    v_exp_f32 v62, v62
    v_exp_f32 v63, v63
    v_exp_f32 v64, v64
    v_exp_f32 v65, v65
    v_mfma_f32_32x32x16_bf16 v[44:59], v[28:31], v[20:23], v[112:127]
    v_exp_f32 v66, v66
    v_exp_f32 v67, v67
    v_exp_f32 v68, v68
    v_exp_f32 v69, v69
    v_smfmac_f32_32x32x32_bf16 v[96:111], v[32:35], v[60:67], v76
    v_mad_i32_i24 v9, v11, s58, v9
    ds_read_b128 v[32:35], v9 offset:0
    v_exp_f32 v70, v70
    v_exp_f32 v71, v71
    v_exp_f32 v72, v72
    v_exp_f32 v73, v73
    v_exp_f32 v74, v74
    v_exp_f32 v75, v75
    s_add_u32 s50, s50, 1
    s_add_u32 s54, s54, 8
    s_cmp_lt_u32 s50, 8
    s_cbranch_scc1 L_at_loop
    v_smfmac_f32_32x32x32_bf16 v[96:111], v[36:39], v[68:75], v76
    s_and_b32 s44, s26, 3
    s_lshl_b32 s44, s44, 12
    s_lshr_b32 s45, s26, 2
    s_lshl_b32 s45, s45, 15
    s_add_u32 s44, s44, s45
    v_add_u32 v8, s44, v1
    v_xor_b32 v9, 32768, v8
    s_and_b32 s44, s26, 3
    v_lshl_add_u32 v6, s44, 2, v2
    s_lshl_b32 s46, s49, 5
    s_add_u32 s46, s46, s48
    s_lshl_b32 s46, s46, 10
    s_add_u32 s55, s46, 6291456
    s_lshl_b32 s44, s49, 1
    s_lshr_b32 s45, s48, 4
    s_add_u32 s44, s44, s45
    s_lshl_b32 s44, s44, 7
    s_add_u32 s56, s44, 14761984
    ds_write_b128 v8, v[96:99] offset:0
    ds_write_b128 v8, v[100:103] offset:1024
    ds_write_b128 v8, v[104:107] offset:2048
    s_waitcnt lgkmcnt(0)
    s_mov_b64 exec, 1
    ds_add_u32 v6, v3 offset:16
    s_mov_b64 exec, -1
    s_mov_b32 s68, 0
L_at_pair:
    ds_read_b32 v4, v6 offset:16
    ds_read_b128 v[96:99], v9 offset:0
    ds_read_b128 v[100:103], v9 offset:1024
    ds_read_b128 v[104:107], v9 offset:2048
    s_add_u32 s68, s68, 1
    s_waitcnt lgkmcnt(0)
    v_cmp_gt_u32 vcc, 2, v4
    s_cmp_gt_u32 s68, 2000000
    s_cbranch_scc1 L_at_pok
    s_cbranch_vccz L_at_pok
    s_sleep 1
    s_branch L_at_pair
L_at_pok:
    v_add_f32 v88, v88, v104
    v_pk_add_f32 v[80:81], v[80:81], v[96:97]
    v_pk_add_f32 v[82:83], v[82:83], v[98:99]
    v_pk_add_f32 v[84:85], v[84:85], v[100:101]
    v_pk_add_f32 v[86:87], v[86:87], v[102:103]
    v_mov_b32 v4, 0x4e800000
    v_cmp_nle_f32 vcc, v88, v4
    v_pk_mul_f32 v[44:45], v[80:81], 0
    v_pk_fma_f32 v[44:45], v[82:83], 0, v[44:45]
    v_pk_fma_f32 v[44:45], v[84:85], 0, v[44:45]
    v_pk_fma_f32 v[44:45], v[86:87], 0, v[44:45]
    v_cmp_u_f32 s[44:45], v44, v45
    v_rcp_f32 v4, v88
    s_nop 2
    s_or_b64 vcc, vcc, s[44:45]
    s_cbranch_vccnz L_at_fallback
L_at_fin:
    v_pk_mul_f32 v[80:81], v[80:81], v[4:5] op_sel_hi:[1,0]
    v_pk_mul_f32 v[82:83], v[82:83], v[4:5] op_sel_hi:[1,0]
    v_pk_mul_f32 v[84:85], v[84:85], v[4:5] op_sel_hi:[1,0]
    v_pk_mul_f32 v[86:87], v[86:87], v[4:5] op_sel_hi:[1,0]
    v_cvt_pk_bf16_f32 v40, v80, v81
    v_cvt_pk_bf16_f32 v41, v82, v83
    v_cvt_pk_bf16_f32 v42, v84, v85
    v_cvt_pk_bf16_f32 v43, v86, v87
    buffer_store_dwordx4 v[40:43], v1, s[28:31], s55 offen sc1
    s_waitcnt vmcnt(0)
    s_mov_b64 exec, 1
    buffer_atomic_add v3, off, s[28:31], s56 sc1
    s_mov_b64 exec, -1
    s_endpgm
L_at_gst:
    s_lshl_b32 s44, s59, 3
    s_add_u32 s44, s44, 14680064
    s_mov_b32 exec_lo, 0
    s_brev_b32 exec_hi, 1
    buffer_store_dwordx4 v[16:19], off, s[28:31], s44 sc1
    s_mov_b64 exec, -1
    s_branch L_at_dmadone
L_at_slow:
    s_mov_b32 s68, 0
L_ats_spin:
    ds_read_b32 v10, v2 offset:4
    s_add_u32 s68, s68, 1
    s_waitcnt lgkmcnt(0)
    v_cmp_gt_u32 vcc, s54, v10
    s_cmp_gt_u32 s68, 2000000
    s_cbranch_scc1 L_ats_ok
    s_cbranch_vccz L_ats_ok
    s_sleep 1
    s_branch L_ats_spin
L_ats_ok:
    s_cmp_lt_u32 s50, 6
    s_branch L_at_back
L_F:
    v_mov_b32 v36, 0
    v_mov_b32 v37, 0
    v_mov_b32 v38, 0
    v_mov_b32 v39, 0
    s_sub_u32 s48, s26, 8
    s_and_b32 s44, s48, 1
    v_mfma_f32_32x32x16_bf16 v[60:75], v[36:39], v[36:39], 0
    v_mfma_f32_32x32x16_bf16 v[76:91], v[36:39], v[36:39], 0
    v_mfma_f32_32x32x16_bf16 v[92:107], v[36:39], v[36:39], 0
    v_mfma_f32_32x32x16_bf16 v[108:123], v[36:39], v[36:39], 0
    s_lshr_b32 s46, s48, 1
    v_and_b32 v4, 31, v0
    v_lshrrev_b32 v5, 5, v0
    v_bfe_u32 v6, v4, 1, 3
    v_xor_b32 v6, v6, v5
    v_lshlrev_b32 v6, 4, v6
    v_lshl_add_u32 v4, v4, 7, v6
    s_lshl_b32 s45, s44, 13
    v_xor_b32 v7, 0, v4
    v_add_u32 v20, s45, v7
    v_xor_b32 v7, 32, v4
    v_add_u32 v21, s45, v7
    v_xor_b32 v7, 64, v4
    v_add_u32 v22, s45, v7
    v_xor_b32 v7, 96, v4
    v_add_u32 v23, s45, v7
    v_bfe_u32 v4, v0, 2, 2
    v_bfe_u32 v6, v0, 4, 1
    v_and_b32 v7, 3, v0
    v_lshlrev_b32 v7, 3, v7
    v_lshl_add_u32 v24, v5, 3, v4
    v_lshl_add_u32 v24, v24, 7, v7
    v_lshlrev_b32 v15, 5, v4
    v_and_b32 v15, 64, v15
    s_lshl_b32 s45, s46, 6
    v_xor_b32 v15, s45, v15
    v_mul_u32_u24 v14, 8224, v6
    v_add3_u32 v24, v24, v14, v15
    v_add_u32 v24, 16384, v24
    s_and_b32 s44, s3, 3
    s_lshl_b32 s44, s44, 2
    s_and_b32 s45, s69, 3
    s_add_u32 s49, s44, s45
    s_lshr_b32 s50, s69, 2
    s_lshr_b32 s44, s3, 2
    s_mul_i32 s44, s44, 6
    s_add_u32 s54, s44, s50
    s_mov_b32 s53, 0
    s_mov_b32 s67, 0
    s_waitcnt lgkmcnt(0)
    s_mov_b32 s28, s24
    s_and_b32 s29, s25, 0xffff
    s_mov_b32 s30, 33554432
    s_mov_b32 s31, 0x20000
    s_cmp_lt_u32 s69, 24
    s_cbranch_scc1 L_E_work
    s_barrier
    s_barrier
    s_barrier
    s_barrier
    s_barrier
    s_barrier
    s_barrier
    s_barrier
    s_branch L_E_late
L_E_work:
    s_setprio 2
    s_barrier
    ds_read_b128 v[28:31], v20 offset:0
    ds_read_b64_tr_b16 v[44:45], v24 offset:0
    ds_read_b64_tr_b16 v[46:47], v24 offset:512
    ds_read_b128 v[32:35], v20 offset:4096
    ds_read_b64_tr_b16 v[48:49], v24 offset:32
    ds_read_b64_tr_b16 v[50:51], v24 offset:544
    s_cmp_ge_u32 s54, 8
    s_cbranch_scc1 L_E_loopV
L_E_loopT:
    s_waitcnt lgkmcnt(3)
    v_mfma_f32_32x32x16_bf16 v[60:75], v[44:47], v[28:31], v[60:75]
    ds_read_b128 v[36:39], v21 offset:0
    ds_read_b64_tr_b16 v[52:53], v24 offset:2048
    s_waitcnt lgkmcnt(4)
    v_mfma_f32_32x32x16_bf16 v[76:91], v[44:47], v[32:35], v[76:91]
    ds_read_b64_tr_b16 v[54:55], v24 offset:2560
    ds_read_b128 v[40:43], v21 offset:4096
    s_waitcnt lgkmcnt(4)
    v_mfma_f32_32x32x16_bf16 v[92:107], v[48:51], v[28:31], v[92:107]
    ds_read_b64_tr_b16 v[56:57], v24 offset:2080
    ds_read_b64_tr_b16 v[58:59], v24 offset:2592
    v_mfma_f32_32x32x16_bf16 v[108:123], v[48:51], v[32:35], v[108:123]
    s_waitcnt lgkmcnt(3)
    v_mfma_f32_32x32x16_bf16 v[60:75], v[52:55], v[36:39], v[60:75]
    ds_read_b128 v[28:31], v22 offset:0
    ds_read_b64_tr_b16 v[44:45], v24 offset:4096
    s_waitcnt lgkmcnt(4)
    v_mfma_f32_32x32x16_bf16 v[76:91], v[52:55], v[40:43], v[76:91]
    ds_read_b64_tr_b16 v[46:47], v24 offset:4608
    ds_read_b128 v[32:35], v22 offset:4096
    s_waitcnt lgkmcnt(4)
    v_mfma_f32_32x32x16_bf16 v[92:107], v[56:59], v[36:39], v[92:107]
    ds_read_b64_tr_b16 v[48:49], v24 offset:4128
    ds_read_b64_tr_b16 v[50:51], v24 offset:4640
    v_mfma_f32_32x32x16_bf16 v[108:123], v[56:59], v[40:43], v[108:123]
    s_waitcnt lgkmcnt(3)
    v_mfma_f32_32x32x16_bf16 v[60:75], v[44:47], v[28:31], v[60:75]
    ds_read_b128 v[36:39], v23 offset:0
    ds_read_b64_tr_b16 v[52:53], v24 offset:6144
    s_waitcnt lgkmcnt(4)
    v_mfma_f32_32x32x16_bf16 v[76:91], v[44:47], v[32:35], v[76:91]
    ds_read_b64_tr_b16 v[54:55], v24 offset:6656
    ds_read_b128 v[40:43], v23 offset:4096
    s_waitcnt lgkmcnt(4)
    v_mfma_f32_32x32x16_bf16 v[92:107], v[48:51], v[28:31], v[92:107]
    ds_read_b64_tr_b16 v[56:57], v24 offset:6176
    ds_read_b64_tr_b16 v[58:59], v24 offset:6688
    v_mfma_f32_32x32x16_bf16 v[108:123], v[48:51], v[32:35], v[108:123]
    s_add_u32 s53, s53, 1
    s_bitcmp1_b32 0x92, s53
    s_mov_b32 s45, 4294934272
    s_cselect_b32 s44, 66048, s45
    s_waitcnt lgkmcnt(3)
    v_mfma_f32_32x32x16_bf16 v[60:75], v[52:55], v[36:39], v[60:75]
    v_add_u32 v20, s44, v20
    v_add_u32 v21, s44, v21
    v_add_u32 v22, s44, v22
    v_add_u32 v23, s44, v23
    v_add_u32 v24, s44, v24
    s_cmp_eq_u32 s53, 8
    s_waitcnt lgkmcnt(0)
    v_mfma_f32_32x32x16_bf16 v[76:91], v[52:55], v[40:43], v[76:91]
    s_cbranch_scc1 L_E_tailT
    s_barrier
    ds_read_b128 v[28:31], v20 offset:0
    ds_read_b64_tr_b16 v[44:45], v24 offset:0
    ds_read_b64_tr_b16 v[46:47], v24 offset:512
    v_mfma_f32_32x32x16_bf16 v[92:107], v[56:59], v[36:39], v[92:107]
    ds_read_b128 v[32:35], v20 offset:4096
    ds_read_b64_tr_b16 v[48:49], v24 offset:32
    ds_read_b64_tr_b16 v[50:51], v24 offset:544
    v_mfma_f32_32x32x16_bf16 v[108:123], v[56:59], v[40:43], v[108:123]
    s_branch L_E_loopT
L_E_tailT:
    v_mfma_f32_32x32x16_bf16 v[92:107], v[56:59], v[36:39], v[92:107]
    v_mfma_f32_32x32x16_bf16 v[108:123], v[56:59], v[40:43], v[108:123]
    v_mov_b32 v4, v1
    s_mov_b32 s47, 262144
    s_branch L_E_epiQ
L_E_loopV:
    s_waitcnt lgkmcnt(3)
    v_mfma_f32_32x32x16_bf16 v[60:75], v[28:31], v[44:47], v[60:75]
    ds_read_b128 v[36:39], v21 offset:0
    ds_read_b64_tr_b16 v[52:53], v24 offset:2048
    s_waitcnt lgkmcnt(4)
    v_mfma_f32_32x32x16_bf16 v[76:91], v[32:35], v[44:47], v[76:91]
    ds_read_b64_tr_b16 v[54:55], v24 offset:2560
    ds_read_b128 v[40:43], v21 offset:4096
    s_waitcnt lgkmcnt(4)
    v_mfma_f32_32x32x16_bf16 v[92:107], v[28:31], v[48:51], v[92:107]
    ds_read_b64_tr_b16 v[56:57], v24 offset:2080
    ds_read_b64_tr_b16 v[58:59], v24 offset:2592
    v_mfma_f32_32x32x16_bf16 v[108:123], v[32:35], v[48:51], v[108:123]
    s_waitcnt lgkmcnt(3)
    v_mfma_f32_32x32x16_bf16 v[60:75], v[36:39], v[52:55], v[60:75]
    ds_read_b128 v[28:31], v22 offset:0
    ds_read_b64_tr_b16 v[44:45], v24 offset:4096
    s_waitcnt lgkmcnt(4)
    v_mfma_f32_32x32x16_bf16 v[76:91], v[40:43], v[52:55], v[76:91]
    ds_read_b64_tr_b16 v[46:47], v24 offset:4608
    ds_read_b128 v[32:35], v22 offset:4096
    s_waitcnt lgkmcnt(4)
    v_mfma_f32_32x32x16_bf16 v[92:107], v[36:39], v[56:59], v[92:107]
    ds_read_b64_tr_b16 v[48:49], v24 offset:4128
    ds_read_b64_tr_b16 v[50:51], v24 offset:4640
    v_mfma_f32_32x32x16_bf16 v[108:123], v[40:43], v[56:59], v[108:123]
    s_waitcnt lgkmcnt(3)
    v_mfma_f32_32x32x16_bf16 v[60:75], v[28:31], v[44:47], v[60:75]
    ds_read_b128 v[36:39], v23 offset:0
    ds_read_b64_tr_b16 v[52:53], v24 offset:6144
    s_waitcnt lgkmcnt(4)
    v_mfma_f32_32x32x16_bf16 v[76:91], v[32:35], v[44:47], v[76:91]
    ds_read_b64_tr_b16 v[54:55], v24 offset:6656
    ds_read_b128 v[40:43], v23 offset:4096
    s_waitcnt lgkmcnt(4)
    v_mfma_f32_32x32x16_bf16 v[92:107], v[28:31], v[48:51], v[92:107]
    ds_read_b64_tr_b16 v[56:57], v24 offset:6176
    ds_read_b64_tr_b16 v[58:59], v24 offset:6688
    v_mfma_f32_32x32x16_bf16 v[108:123], v[32:35], v[48:51], v[108:123]
    s_add_u32 s53, s53, 1
    s_bitcmp1_b32 0x92, s53
    s_mov_b32 s45, 4294934272
    s_cselect_b32 s44, 66048, s45
    s_waitcnt lgkmcnt(3)
    v_mfma_f32_32x32x16_bf16 v[60:75], v[36:39], v[52:55], v[60:75]
    v_add_u32 v20, s44, v20
    v_add_u32 v21, s44, v21
    v_add_u32 v22, s44, v22
    v_add_u32 v23, s44, v23
    v_add_u32 v24, s44, v24
    s_cmp_eq_u32 s53, 8
    s_waitcnt lgkmcnt(0)
    v_mfma_f32_32x32x16_bf16 v[76:91], v[40:43], v[52:55], v[76:91]
    s_cbranch_scc1 L_E_tailV
    s_barrier
    ds_read_b128 v[28:31], v20 offset:0
    ds_read_b64_tr_b16 v[44:45], v24 offset:0
    ds_read_b64_tr_b16 v[46:47], v24 offset:512
    v_mfma_f32_32x32x16_bf16 v[92:107], v[36:39], v[56:59], v[92:107]
    ds_read_b128 v[32:35], v20 offset:4096
    ds_read_b64_tr_b16 v[48:49], v24 offset:32
    ds_read_b64_tr_b16 v[50:51], v24 offset:544
    v_mfma_f32_32x32x16_bf16 v[108:123], v[40:43], v[56:59], v[108:123]
    s_branch L_E_loopV
L_E_tailV:
    v_mfma_f32_32x32x16_bf16 v[92:107], v[36:39], v[56:59], v[92:107]
    v_mfma_f32_32x32x16_bf16 v[108:123], v[40:43], v[56:59], v[108:123]
    v_and_b32 v4, 15, v0
    v_lshlrev_b32 v4, 4, v4
    v_lshrrev_b32 v5, 5, v0
    v_lshl_add_u32 v4, v5, 8, v4
    v_bfe_u32 v5, v0, 4, 1
    v_lshl_add_u32 v4, v5, 18, v4
    s_mov_b32 s47, 512
L_E_epiQ:
    s_lshl_b32 s44, s54, 19
    s_lshr_b32 s45, s48, 1
    s_lshl_b32 s45, s45, 17
    s_add_u32 s44, s44, s45
    s_lshl_b32 s45, s49, 12
    s_add_u32 s44, s44, s45
    s_and_b32 s45, s48, 1
    s_lshl_b32 s45, s45, 11
    s_add_u32 s44, s44, s45
    s_add_u32 s45, s44, s47
    s_cmp_lt_u32 s54, 4
    s_cbranch_scc0 L_E_noscale
    s_mov_b32 s46, 0x3eb8aa3b
    s_mov_b32 s47, s46
    v_pk_mul_f32 v[60:61], v[60:61], s[46:47]
    v_pk_mul_f32 v[62:63], v[62:63], s[46:47]
    v_pk_mul_f32 v[64:65], v[64:65], s[46:47]
    v_pk_mul_f32 v[66:67], v[66:67], s[46:47]
    v_pk_mul_f32 v[68:69], v[68:69], s[46:47]
    v_pk_mul_f32 v[70:71], v[70:71], s[46:47]
    v_pk_mul_f32 v[72:73], v[72:73], s[46:47]
    v_pk_mul_f32 v[74:75], v[74:75], s[46:47]
    v_pk_mul_f32 v[76:77], v[76:77], s[46:47]
    v_pk_mul_f32 v[78:79], v[78:79], s[46:47]
    v_pk_mul_f32 v[80:81], v[80:81], s[46:47]
    v_pk_mul_f32 v[82:83], v[82:83], s[46:47]
    v_pk_mul_f32 v[84:85], v[84:85], s[46:47]
    v_pk_mul_f32 v[86:87], v[86:87], s[46:47]
    v_pk_mul_f32 v[88:89], v[88:89], s[46:47]
    v_pk_mul_f32 v[90:91], v[90:91], s[46:47]
    v_pk_mul_f32 v[92:93], v[92:93], s[46:47]
    v_pk_mul_f32 v[94:95], v[94:95], s[46:47]
    v_pk_mul_f32 v[96:97], v[96:97], s[46:47]
    v_pk_mul_f32 v[98:99], v[98:99], s[46:47]
    v_pk_mul_f32 v[100:101], v[100:101], s[46:47]
    v_pk_mul_f32 v[102:103], v[102:103], s[46:47]
    v_pk_mul_f32 v[104:105], v[104:105], s[46:47]
    v_pk_mul_f32 v[106:107], v[106:107], s[46:47]
    v_pk_mul_f32 v[108:109], v[108:109], s[46:47]
    v_pk_mul_f32 v[110:111], v[110:111], s[46:47]
    v_pk_mul_f32 v[112:113], v[112:113], s[46:47]
    v_pk_mul_f32 v[114:115], v[114:115], s[46:47]
    v_pk_mul_f32 v[116:117], v[116:117], s[46:47]
    v_pk_mul_f32 v[118:119], v[118:119], s[46:47]
    v_pk_mul_f32 v[120:121], v[120:121], s[46:47]
    v_pk_mul_f32 v[122:123], v[122:123], s[46:47]
L_E_noscale:
    v_cvt_pk_bf16_f32 v124, v60, v61
    v_cvt_pk_bf16_f32 v125, v62, v63
    v_cvt_pk_bf16_f32 v126, v64, v65
    v_cvt_pk_bf16_f32 v127, v66, v67
    buffer_store_dwordx4 v[124:127], v4, s[28:31], s44 offen offset:0 sc1
    v_cvt_pk_bf16_f32 v128, v68, v69
    v_cvt_pk_bf16_f32 v129, v70, v71
    v_cvt_pk_bf16_f32 v130, v72, v73
    v_cvt_pk_bf16_f32 v131, v74, v75
    buffer_store_dwordx4 v[128:131], v4, s[28:31], s45 offen offset:0 sc1
    v_cvt_pk_bf16_f32 v132, v76, v77
    v_cvt_pk_bf16_f32 v133, v78, v79
    v_cvt_pk_bf16_f32 v134, v80, v81
    v_cvt_pk_bf16_f32 v135, v82, v83
    buffer_store_dwordx4 v[132:135], v4, s[28:31], s44 offen offset:1024 sc1
    v_cvt_pk_bf16_f32 v136, v84, v85
    v_cvt_pk_bf16_f32 v137, v86, v87
    v_cvt_pk_bf16_f32 v138, v88, v89
    v_cvt_pk_bf16_f32 v139, v90, v91
    buffer_store_dwordx4 v[136:139], v4, s[28:31], s45 offen offset:1024 sc1
    s_add_u32 s44, s44, 65536
    s_add_u32 s45, s45, 65536
    v_cvt_pk_bf16_f32 v124, v92, v93
    v_cvt_pk_bf16_f32 v125, v94, v95
    v_cvt_pk_bf16_f32 v126, v96, v97
    v_cvt_pk_bf16_f32 v127, v98, v99
    buffer_store_dwordx4 v[124:127], v4, s[28:31], s44 offen offset:0 sc1
    v_cvt_pk_bf16_f32 v128, v100, v101
    v_cvt_pk_bf16_f32 v129, v102, v103
    v_cvt_pk_bf16_f32 v130, v104, v105
    v_cvt_pk_bf16_f32 v131, v106, v107
    buffer_store_dwordx4 v[128:131], v4, s[28:31], s45 offen offset:0 sc1
    v_cvt_pk_bf16_f32 v132, v108, v109
    v_cvt_pk_bf16_f32 v133, v110, v111
    v_cvt_pk_bf16_f32 v134, v112, v113
    v_cvt_pk_bf16_f32 v135, v114, v115
    buffer_store_dwordx4 v[132:135], v4, s[28:31], s44 offen offset:1024 sc1
    v_cvt_pk_bf16_f32 v136, v116, v117
    v_cvt_pk_bf16_f32 v137, v118, v119
    v_cvt_pk_bf16_f32 v138, v120, v121
    v_cvt_pk_bf16_f32 v139, v122, v123
    buffer_store_dwordx4 v[136:139], v4, s[28:31], s45 offen offset:1024 sc1
    s_and_b32 s44, s54, 3
    s_lshl_b32 s44, s44, 1
    s_lshr_b32 s45, s48, 1
    s_add_u32 s44, s44, s45
    s_lshl_b32 s44, s44, 3
    s_lshr_b32 s45, s54, 2
    s_lshl_b32 s45, s45, 1
    s_add_u32 s44, s44, s45
    s_and_b32 s45, s48, 1
    s_add_u32 s44, s44, s45
    s_lshl_b32 s44, s44, 7
    s_add_u32 s59, s44, 14745600
L_E_late:
    s_mov_b64 exec, 1
    ds_add_u32 v2, v3 offset:36
    s_mov_b64 exec, -1
    v_and_b32 v4, 31, v0
    v_lshrrev_b32 v5, 5, v0
    v_bfe_u32 v6, v4, 1, 3
    v_xor_b32 v6, v6, v5
    v_lshlrev_b32 v6, 4, v6
    v_lshl_add_u32 v4, v4, 7, v6
    s_and_b32 s44, s48, 1
    s_lshl_b32 s47, s44, 13
    s_add_u32 s47, s47, 49152
    v_xor_b32 v7, 0, v4
    v_add_u32 v16, s47, v7
    v_xor_b32 v7, 32, v4
    v_add_u32 v17, s47, v7
    v_xor_b32 v7, 64, v4
    v_add_u32 v18, s47, v7
    v_xor_b32 v7, 96, v4
    v_add_u32 v19, s47, v7
    v_bfe_u32 v4, v0, 2, 2
    v_bfe_u32 v6, v0, 4, 1
    v_and_b32 v7, 3, v0
    v_lshlrev_b32 v7, 3, v7
    v_lshl_add_u32 v12, v5, 3, v4
    v_mul_u32_u24 v12, 192, v12
    v_mul_u32_u24 v14, 12320, v6
    v_add3_u32 v12, v12, v14, v7
    v_add_u32 v12, 106752, v12
    v_lshl_add_u32 v7, v6, 5, v7
    v_lshl_add_u32 v4, v5, 2, v4
    v_lshl_add_u32 v7, v4, 7, v7
    v_add_u32 v15, v15, v7
    s_lshl_b32 s62, s48, 14
    s_add_u32 s62, s62, 65536
    s_lshl_b32 s44, s3, 2
    s_and_b32 s45, s69, 3
    s_add_u32 s60, s44, s45
    s_lshr_b32 s61, s69, 2
    v_lshrrev_b32 v4, 3, v0
    v_and_b32 v5, 7, v0
    v_lshlrev_b32 v7, 1, v4
    v_and_b32 v7, 4, v7
    v_xor_b32 v7, v5, v7
    v_lshlrev_b32 v7, 4, v7
    v_lshl_add_u32 v7, v4, 10, v7
    s_lshl_b32 s44, s61, 7
    v_add_u32 v14, s44, v7
    v_lshrrev_b32 v4, 3, v0
    v_and_b32 v5, 7, v0
    v_lshrrev_b32 v6, 1, v4
    s_and_b32 s44, s3, 2
    s_lshl_b32 s44, s44, 2
    s_and_b32 s45, s69, 7
    s_add_u32 s51, s44, s45
    s_lshr_b32 s44, s3, 2
    s_mul_i32 s44, s44, 43
    s_and_b32 s45, s3, 1
    s_mul_i32 s45, s45, 24
    s_add_u32 s55, s44, s45
    s_and_b32 s44, s3, 1
    s_sub_u32 s52, 6, s44
    s_lshr_b32 s45, s69, 3
    s_mul_i32 s47, s45, s52
    s_add_u32 s55, s55, s47
    s_cmp_eq_u32 s45, 3
    s_cselect_b32 s44, s44, 0
    s_sub_u32 s52, s52, s44
    s_and_b32 s46, s48, 1
    s_lshl_b32 s45, s46, 2
    v_or_b32 v6, s45, v6
    v_xor_b32 v5, v5, v6
    v_lshlrev_b32 v5, 4, v5
    s_lshl_b32 s44, s51, 7
    s_lshl_b32 s45, s48, 3
    s_add_u32 s44, s44, s45
    v_add_u32 v4, s44, v4
    v_lshl_add_u32 v8, v4, 10, v5
    s_movk_i32 s44, 5462
    s_movk_i32 s47, 2752
    s_lshl_b32 s45, s46, 5
    v_add_u32 v4, 0, v0
    v_mul_u32_u24 v5, s44, v4
    v_lshrrev_b32 v5, 16, v5
    v_mul_u32_u24 v6, 12, v5
    v_sub_u32 v6, v4, v6
    v_lshrrev_b32 v4, 1, v6
    v_cmp_gt_u32 vcc, s52, v4
    v_lshlrev_b32 v6, 4, v6
    v_add_u32 v5, s45, v5
    v_mad_u32_u24 v9, v5, s47, v6
    v_bfrev_b32 v4, 2
    v_cndmask_b32 v9, v4, v9, vcc
    v_add_u32 v4, 64, v0
    v_mul_u32_u24 v5, s44, v4
    v_lshrrev_b32 v5, 16, v5
    v_mul_u32_u24 v6, 12, v5
    v_sub_u32 v6, v4, v6
    v_lshrrev_b32 v4, 1, v6
    v_cmp_gt_u32 vcc, s52, v4
    v_lshlrev_b32 v6, 4, v6
    v_add_u32 v5, s45, v5
    v_mad_u32_u24 v10, v5, s47, v6
    v_bfrev_b32 v4, 2
    v_cndmask_b32 v10, v4, v10, vcc
    v_add_u32 v4, 128, v0
    v_mul_u32_u24 v5, s44, v4
    v_lshrrev_b32 v5, 16, v5
    v_mul_u32_u24 v6, 12, v5
    v_sub_u32 v6, v4, v6
    v_lshrrev_b32 v4, 1, v6
    v_cmp_gt_u32 vcc, s52, v4
    v_lshlrev_b32 v6, 4, v6
    v_add_u32 v5, s45, v5
    v_mad_u32_u24 v11, v5, s47, v6
    v_bfrev_b32 v4, 2
    v_cndmask_b32 v11, v4, v11, vcc
    s_lshl_b32 s63, s48, 10
    s_add_u32 s63, s63, 49152
    s_mul_i32 s45, s46, 6144
    s_lshr_b32 s46, s48, 1
    s_mul_i32 s47, s46, 12320
    s_add_u32 s45, s45, s47
    s_add_u32 s64, s45, 81920
    s_mov_b32 s44, 0
    s_lshl_b32 s65, s44, 7
    s_mul_i32 s66, s44, 176128
    s_lshr_b32 s46, s48, 1
    s_cmp_eq_u32 s52, 4
    s_cselect_b32 s44, 2, 3
    s_mul_i32 s44, s44, s46
    s_lshl_b32 s47, 1, s46
    s_cmp_eq_u32 s52, 5
    s_cselect_b32 s56, s47, 0
    s_cmp_eq_u32 s52, 6
    s_cselect_b32 s56, 3, s56
    s_cselect_b32 s45, s44, 0
    s_add_u32 s45, s45, 2
    s_lshl_b32 s47, s45, 5
    v_add_u32 v13, s47, v12
    s_lshl_b32 s47, s44, 5
    v_add_u32 v12, s47, v12
    s_lshl_b32 s45, s45, 8
    s_add_u32 s52, s45, s44
    s_mov_b32 s57, 16384
    s_add_u32 s58, s64, 74496
    s_mov_b32 s32, s4
    s_and_b32 s33, s5, 0xffff
    s_mov_b32 s34, 2097152
    s_mov_b32 s35, 0x20000
    s_cmp_lt_u32 s48, 2
    s_cselect_b32 s46, s12, s14
    s_cselect_b32 s47, s13, s15
    s_lshl_b32 s44, s55, 5
    s_add_u32 s36, s46, s44
    s_addc_u32 s37, s47, 0
    s_and_b32 s37, s37, 0xffff
    s_sub_u32 s38, 1409024, s44
    s_mov_b32 s39, 0x20000
    s_movk_i32 s65, 256
    s_mov_b32 s66, 352256
    v_mov_b32 v48, 0
    v_mov_b32 v49, 0
    v_pk_mov_b32 v[50:51], v[48:49], v[48:49]
    v_pk_mov_b32 v[52:53], v[48:49], v[48:49]
    v_pk_mov_b32 v[54:55], v[48:49], v[48:49]
    v_pk_mov_b32 v[56:57], v[48:49], v[48:49]
    v_pk_mov_b32 v[58:59], v[48:49], v[48:49]
    v_pk_mov_b32 v[60:61], v[48:49], v[48:49]
    v_pk_mov_b32 v[62:63], v[48:49], v[48:49]
    v_pk_mov_b32 v[64:65], v[48:49], v[48:49]
    v_pk_mov_b32 v[66:67], v[48:49], v[48:49]
    v_pk_mov_b32 v[68:69], v[48:49], v[48:49]
    v_pk_mov_b32 v[70:71], v[48:49], v[48:49]
    v_pk_mov_b32 v[72:73], v[48:49], v[48:49]
    v_pk_mov_b32 v[74:75], v[48:49], v[48:49]
    v_pk_mov_b32 v[76:77], v[48:49], v[48:49]
    v_pk_mov_b32 v[78:79], v[48:49], v[48:49]
    v_pk_mov_b32 v[80:81], v[48:49], v[48:49]
    v_pk_mov_b32 v[82:83], v[48:49], v[48:49]
    v_pk_mov_b32 v[84:85], v[48:49], v[48:49]
    v_pk_mov_b32 v[86:87], v[48:49], v[48:49]
    v_pk_mov_b32 v[88:89], v[48:49], v[48:49]
    v_pk_mov_b32 v[90:91], v[48:49], v[48:49]
    v_pk_mov_b32 v[92:93], v[48:49], v[48:49]
    v_pk_mov_b32 v[94:95], v[48:49], v[48:49]
    v_pk_mov_b32 v[96:97], v[48:49], v[48:49]
    v_pk_mov_b32 v[98:99], v[48:49], v[48:49]
    v_pk_mov_b32 v[100:101], v[48:49], v[48:49]
    v_pk_mov_b32 v[102:103], v[48:49], v[48:49]
    v_pk_mov_b32 v[104:105], v[48:49], v[48:49]
    v_pk_mov_b32 v[106:107], v[48:49], v[48:49]
    v_pk_mov_b32 v[108:109], v[48:49], v[48:49]
    v_pk_mov_b32 v[110:111], v[48:49], v[48:49]
    v_pk_mov_b32 v[112:113], v[48:49], v[48:49]
    v_pk_mov_b32 v[114:115], v[48:49], v[48:49]
    v_pk_mov_b32 v[116:117], v[48:49], v[48:49]
    v_pk_mov_b32 v[118:119], v[48:49], v[48:49]
    v_pk_mov_b32 v[120:121], v[48:49], v[48:49]
    v_pk_mov_b32 v[122:123], v[48:49], v[48:49]
    v_pk_mov_b32 v[124:125], v[48:49], v[48:49]
    v_pk_mov_b32 v[126:127], v[48:49], v[48:49]
    v_pk_mov_b32 v[128:129], v[48:49], v[48:49]
    v_pk_mov_b32 v[130:131], v[48:49], v[48:49]
    v_pk_mov_b32 v[132:133], v[48:49], v[48:49]
    v_pk_mov_b32 v[134:135], v[48:49], v[48:49]
    v_pk_mov_b32 v[136:137], v[48:49], v[48:49]
    v_pk_mov_b32 v[138:139], v[48:49], v[48:49]
    v_pk_mov_b32 v[140:141], v[48:49], v[48:49]
    v_pk_mov_b32 v[142:143], v[48:49], v[48:49]
    s_mov_b32 s53, 0
    s_mov_b32 s49, 16384
    s_mov_b32 s50, 24832
    s_mov_b32 s68, 0
L_tg1_spin:
    ds_read_b32 v5, v2 offset:0
    s_add_u32 s68, s68, 1
    s_waitcnt lgkmcnt(0)
    v_cmp_gt_u32 vcc, 1, v5
    s_cmp_gt_u32 s68, 2000000
    s_cbranch_scc1 L_tg1_ok
    s_cbranch_vccz L_tg1_ok
    s_sleep 1
    s_branch L_tg1_spin
L_tg1_ok:
    s_cmp_lt_u32 s69, 24
    s_cbranch_scc0 L_E_done2
    s_waitcnt vmcnt(0)
    s_mov_b64 exec, 1
    buffer_atomic_add v3, off, s[28:31], s59 sc1
    s_mov_b64 exec, -1
L_E_done2:
    s_mov_b64 exec, 1
    ds_add_u32 v2, v3 offset:32
    s_mov_b64 exec, -1
    s_mov_b32 s68, 0
L_u0_spin:
    ds_read_b32 v4, v2 offset:40
    s_add_u32 s68, s68, 1
    s_waitcnt lgkmcnt(0)
    v_cmp_gt_u32 vcc, 4, v4
    s_cmp_gt_u32 s68, 2000000
    s_cbranch_scc1 L_u0_ok
    s_cbranch_vccz L_u0_ok
    s_sleep 1
    s_branch L_u0_spin
L_u0_ok:
    ds_read_b128 v[20:23], v16 offset:0
    ds_read_b128 v[24:27], v16 offset:4096
    ds_read_b64_tr_b16 v[36:37], v12 offset:0
    ds_read_b64_tr_b16 v[38:39], v12 offset:768
    ds_read_b64_tr_b16 v[40:41], v12 offset:32
    ds_read_b64_tr_b16 v[42:43], v12 offset:800
    ds_read_b64_tr_b16 v[44:45], v13 offset:0
    ds_read_b64_tr_b16 v[46:47], v13 offset:768
L_ub_loop:
    s_waitcnt lgkmcnt(4)
    v_mfma_f32_32x32x16_bf16 v[48:63], v[36:39], v[20:23], v[48:63]
    v_mfma_f32_32x32x16_bf16 v[64:79], v[36:39], v[24:27], v[64:79]
    ds_read_b128 v[28:31], v17 offset:0
    ds_read_b128 v[32:35], v17 offset:4096
    ds_read_b64_tr_b16 v[36:37], v12 offset:3072
    ds_read_b64_tr_b16 v[38:39], v12 offset:3840
    s_waitcnt lgkmcnt(6)
    v_mfma_f32_32x32x16_bf16 v[80:95], v[40:43], v[20:23], v[80:95]
    v_mfma_f32_32x32x16_bf16 v[96:111], v[40:43], v[24:27], v[96:111]
    ds_read_b64_tr_b16 v[40:41], v12 offset:3104
    ds_read_b64_tr_b16 v[42:43], v12 offset:3872
    s_waitcnt lgkmcnt(6)
    s_bitcmp1_b32 s56, 0
    s_cbranch_scc0 L_upskip_3
    v_mfma_f32_32x32x16_bf16 v[112:127], v[44:47], v[20:23], v[112:127]
L_upskip_3:
    s_bitcmp1_b32 s56, 1
    s_cbranch_scc0 L_upskip_4
    v_mfma_f32_32x32x16_bf16 v[128:143], v[44:47], v[24:27], v[128:143]
L_upskip_4:
    ds_read_b64_tr_b16 v[44:45], v13 offset:3072
    ds_read_b64_tr_b16 v[46:47], v13 offset:3840
    s_waitcnt lgkmcnt(4)
    v_mfma_f32_32x32x16_bf16 v[48:63], v[36:39], v[28:31], v[48:63]
    v_mfma_f32_32x32x16_bf16 v[64:79], v[36:39], v[32:35], v[64:79]
    ds_read_b128 v[20:23], v18 offset:0
    ds_read_b128 v[24:27], v18 offset:4096
    ds_read_b64_tr_b16 v[36:37], v12 offset:6144
    ds_read_b64_tr_b16 v[38:39], v12 offset:6912
    s_waitcnt lgkmcnt(6)
    v_mfma_f32_32x32x16_bf16 v[80:95], v[40:43], v[28:31], v[80:95]
    v_mfma_f32_32x32x16_bf16 v[96:111], v[40:43], v[32:35], v[96:111]
    ds_read_b64_tr_b16 v[40:41], v12 offset:6176
    ds_read_b64_tr_b16 v[42:43], v12 offset:6944
    s_waitcnt lgkmcnt(6)
    s_bitcmp1_b32 s56, 0
    s_cbranch_scc0 L_upskip_5
    v_mfma_f32_32x32x16_bf16 v[112:127], v[44:47], v[28:31], v[112:127]
L_upskip_5:
    s_bitcmp1_b32 s56, 1
    s_cbranch_scc0 L_upskip_6
    v_mfma_f32_32x32x16_bf16 v[128:143], v[44:47], v[32:35], v[128:143]
L_upskip_6:
    ds_read_b64_tr_b16 v[44:45], v13 offset:6144
    ds_read_b64_tr_b16 v[46:47], v13 offset:6912
    s_waitcnt lgkmcnt(4)
    v_mfma_f32_32x32x16_bf16 v[48:63], v[36:39], v[20:23], v[48:63]
    v_mfma_f32_32x32x16_bf16 v[64:79], v[36:39], v[24:27], v[64:79]
    ds_read_b128 v[28:31], v19 offset:0
    ds_read_b128 v[32:35], v19 offset:4096
    ds_read_b64_tr_b16 v[36:37], v12 offset:9216
    ds_read_b64_tr_b16 v[38:39], v12 offset:9984
    s_waitcnt lgkmcnt(6)
    v_mfma_f32_32x32x16_bf16 v[80:95], v[40:43], v[20:23], v[80:95]
    v_mfma_f32_32x32x16_bf16 v[96:111], v[40:43], v[24:27], v[96:111]
    ds_read_b64_tr_b16 v[40:41], v12 offset:9248
    ds_read_b64_tr_b16 v[42:43], v12 offset:10016
    s_waitcnt lgkmcnt(6)
    s_bitcmp1_b32 s56, 0
    s_cbranch_scc0 L_upskip_7
    v_mfma_f32_32x32x16_bf16 v[112:127], v[44:47], v[20:23], v[112:127]
L_upskip_7:
    s_bitcmp1_b32 s56, 1
    s_cbranch_scc0 L_upskip_8
    v_mfma_f32_32x32x16_bf16 v[128:143], v[44:47], v[24:27], v[128:143]
L_upskip_8:
    ds_read_b64_tr_b16 v[44:45], v13 offset:9216
    ds_read_b64_tr_b16 v[46:47], v13 offset:9984
    s_waitcnt lgkmcnt(4)
    v_mfma_f32_32x32x16_bf16 v[48:63], v[36:39], v[28:31], v[48:63]
    v_mfma_f32_32x32x16_bf16 v[64:79], v[36:39], v[32:35], v[64:79]
    s_waitcnt lgkmcnt(2)
    v_mfma_f32_32x32x16_bf16 v[80:95], v[40:43], v[28:31], v[80:95]
    v_mfma_f32_32x32x16_bf16 v[96:111], v[40:43], v[32:35], v[96:111]
    s_waitcnt lgkmcnt(0)
    s_bitcmp1_b32 s56, 0
    s_cbranch_scc0 L_upskip_9
    v_mfma_f32_32x32x16_bf16 v[112:127], v[44:47], v[28:31], v[112:127]
L_upskip_9:
    s_bitcmp1_b32 s56, 1
    s_cbranch_scc0 L_upskip_10
    v_mfma_f32_32x32x16_bf16 v[128:143], v[44:47], v[32:35], v[128:143]
L_upskip_10:
    v_add_u32 v16, s49, v16
    v_add_u32 v17, s49, v17
    v_add_u32 v18, s49, v18
    v_add_u32 v19, s49, v19
    v_add_u32 v12, s50, v12
    v_add_u32 v13, s50, v13
    s_sub_u32 s49, 0, s49
    s_add_u32 s53, s53, 1
    s_bitcmp1_b32 0x12, s53
    s_mov_b32 s44, 4294917632
    s_cselect_b32 s50, s44, 24832
    s_setprio 2
    s_cmp_eq_u32 s53, 1
    s_cbranch_scc0 L_ub_n1
    s_add_u32 s67, s67, 4
    s_mov_b64 exec, 1
    ds_add_u32 v2, v3 offset:8
    s_mov_b64 exec, -1
    s_mov_b32 s68, 0
L_fb_11_spin:
    ds_read_b32 v4, v2 offset:8
    s_add_u32 s68, s68, 1
    s_waitcnt lgkmcnt(0)
    v_cmp_gt_u32 vcc, s67, v4
    s_cmp_gt_u32 s68, 2000000
    s_cbranch_scc1 L_fb_11_ok
    s_cbranch_vccz L_fb_11_ok
    s_sleep 2
    s_branch L_fb_11_spin
L_fb_11_ok:
    s_mov_b32 s68, 0
L_u1_spin:
    ds_read_b32 v4, v2 offset:36
    s_add_u32 s68, s68, 1
    s_waitcnt lgkmcnt(0)
    v_cmp_gt_u32 vcc, 8, v4
    s_cmp_gt_u32 s68, 2000000
    s_cbranch_scc1 L_u1_ok
    s_cbranch_vccz L_u1_ok
    s_sleep 1
    s_branch L_u1_spin
L_u1_ok:
    s_branch L_ub_n3
L_ub_n1:
    s_cmp_eq_u32 s53, 2
    s_cbranch_scc1 L_ub_n4
    s_waitcnt vmcnt(0)
    s_branch L_ub_n2
L_ub_n4:
    s_mov_b32 s68, 0
L_upb2_spin:
    ds_read_b32 v4, v2 offset:4
    s_add_u32 s68, s68, 1
    s_waitcnt lgkmcnt(0)
    v_cmp_gt_u32 vcc, 8, v4
    s_cmp_gt_u32 s68, 2000000
    s_cbranch_scc1 L_upb2_ok
    s_cbranch_vccz L_upb2_ok
    s_sleep 2
    s_branch L_upb2_spin
L_upb2_ok:
    s_mov_b32 m0, s63
    s_mov_b32 s46, s65
    buffer_load_dwordx4 v8, s[32:35], s46 offen lds
    s_add_u32 m0, m0, 4096
    s_add_u32 s46, s46, 32768
    buffer_load_dwordx4 v8, s[32:35], s46 offen lds
    s_add_u32 m0, m0, 4096
    s_add_u32 s46, s46, 32768
    buffer_load_dwordx4 v8, s[32:35], s46 offen lds
    s_add_u32 m0, m0, 4096
    s_add_u32 s46, s46, 32768
    buffer_load_dwordx4 v8, s[32:35], s46 offen lds
    s_add_u32 s65, s65, 128
    s_and_b32 s65, s65, 1023
    s_add_u32 s63, s63, s57
    s_sub_u32 s57, 0, s57
    s_mov_b32 m0, s64
    s_add_u32 s46, s66, 44032
    buffer_load_dwordx4 v9, s[36:39], s66 offen lds
    s_add_u32 m0, m0, 1024
    s_nop 0
    buffer_load_dwordx4 v10, s[36:39], s66 offen lds
    s_add_u32 m0, m0, 1024
    s_nop 0
    buffer_load_dwordx4 v11, s[36:39], s66 offen lds
    s_add_u32 m0, m0, 1024
    s_nop 0
    buffer_load_dwordx4 v9, s[36:39], s46 offen lds
    s_add_u32 m0, m0, 1024
    s_nop 0
    buffer_load_dwordx4 v10, s[36:39], s46 offen lds
    s_add_u32 m0, m0, 1024
    s_nop 0
    buffer_load_dwordx4 v11, s[36:39], s46 offen lds
    s_add_u32 s66, s66, 176128
    s_cmp_eq_u32 s66, 1409024
    s_cselect_b32 s66, 0, s66
    s_add_u32 s64, s64, 24832
    s_cmp_eq_u32 s64, s58
    s_cselect_b32 s44, 74496, 0
    s_sub_u32 s64, s64, s44
    s_mov_b32 m0, s64
    s_add_u32 s46, s66, 44032
    buffer_load_dwordx4 v9, s[36:39], s66 offen lds
    s_add_u32 m0, m0, 1024
    s_nop 0
    buffer_load_dwordx4 v10, s[36:39], s66 offen lds
    s_add_u32 m0, m0, 1024
    s_nop 0
    buffer_load_dwordx4 v11, s[36:39], s66 offen lds
    s_add_u32 m0, m0, 1024
    s_nop 0
    buffer_load_dwordx4 v9, s[36:39], s46 offen lds
    s_add_u32 m0, m0, 1024
    s_nop 0
    buffer_load_dwordx4 v10, s[36:39], s46 offen lds
    s_add_u32 m0, m0, 1024
    s_nop 0
    buffer_load_dwordx4 v11, s[36:39], s46 offen lds
    s_add_u32 s66, s66, 176128
    s_cmp_eq_u32 s66, 1409024
    s_cselect_b32 s66, 0, s66
    s_add_u32 s64, s64, 24832
    s_cmp_eq_u32 s64, s58
    s_cselect_b32 s44, 74496, 0
    s_sub_u32 s64, s64, s44
    s_waitcnt vmcnt(6)
L_ub_n2:
    s_add_u32 s67, s67, 4
    s_mov_b64 exec, 1
    ds_add_u32 v2, v3 offset:8
    s_mov_b64 exec, -1
    s_mov_b32 s68, 0
L_fb_12_spin:
    ds_read_b32 v4, v2 offset:8
    s_add_u32 s68, s68, 1
    s_waitcnt lgkmcnt(0)
    v_cmp_gt_u32 vcc, s67, v4
    s_cmp_gt_u32 s68, 2000000
    s_cbranch_scc1 L_fb_12_ok
    s_cbranch_vccz L_fb_12_ok
    s_sleep 2
    s_branch L_fb_12_spin
L_fb_12_ok:
L_ub_n3:
    s_setprio 0
    ds_read_b128 v[20:23], v16 offset:0
    ds_read_b128 v[24:27], v16 offset:4096
    ds_read_b64_tr_b16 v[36:37], v12 offset:0
    ds_read_b64_tr_b16 v[38:39], v12 offset:768
    ds_read_b64_tr_b16 v[40:41], v12 offset:32
    ds_read_b64_tr_b16 v[42:43], v12 offset:800
    ds_read_b64_tr_b16 v[44:45], v13 offset:0
    ds_read_b64_tr_b16 v[46:47], v13 offset:768
    s_cmp_lt_u32 s53, 2
    s_cbranch_scc1 L_ub_loop
    s_mov_b32 s40, s16
    s_and_b32 s41, s17, 0xffff
    s_mov_b32 s42, 1409024
    s_mov_b32 s43, 0x20000
    s_lshl_b32 s44, s69, 2
    s_add_u32 s44, s44, s48
    s_lshl_b32 s54, s44, 10
    s_mov_b32 s59, s54
L_up_loop:
    s_waitcnt lgkmcnt(4)
    v_mfma_f32_32x32x16_bf16 v[48:63], v[36:39], v[20:23], v[48:63]
    s_mov_b32 m0, s63
    s_mov_b32 s46, s65
    buffer_load_dwordx4 v8, s[32:35], s46 offen lds
    v_mfma_f32_32x32x16_bf16 v[64:79], v[36:39], v[24:27], v[64:79]
    s_add_u32 m0, m0, 4096
    s_add_u32 s46, s46, 32768
    buffer_load_dwordx4 v8, s[32:35], s46 offen lds
    ds_read_b128 v[28:31], v17 offset:0
    ds_read_b128 v[32:35], v17 offset:4096
    ds_read_b64_tr_b16 v[36:37], v12 offset:3072
    ds_read_b64_tr_b16 v[38:39], v12 offset:3840
    s_waitcnt lgkmcnt(6)
    v_mfma_f32_32x32x16_bf16 v[80:95], v[40:43], v[20:23], v[80:95]
    s_add_u32 m0, m0, 4096
    s_add_u32 s46, s46, 32768
    buffer_load_dwordx4 v8, s[32:35], s46 offen lds
    v_mfma_f32_32x32x16_bf16 v[96:111], v[40:43], v[24:27], v[96:111]
    s_add_u32 m0, m0, 4096
    s_add_u32 s46, s46, 32768
    buffer_load_dwordx4 v8, s[32:35], s46 offen lds
    s_add_u32 s65, s65, 128
    s_and_b32 s65, s65, 1023
    s_add_u32 s63, s63, s57
    s_sub_u32 s57, 0, s57
    ds_read_b64_tr_b16 v[40:41], v12 offset:3104
    ds_read_b64_tr_b16 v[42:43], v12 offset:3872
    s_waitcnt lgkmcnt(6)
    s_bitcmp1_b32 s56, 0
    s_cbranch_scc0 L_upskip_13
    v_mfma_f32_32x32x16_bf16 v[112:127], v[44:47], v[20:23], v[112:127]
L_upskip_13:
    s_bitcmp1_b32 s56, 1
    s_cbranch_scc0 L_upskip_14
    v_mfma_f32_32x32x16_bf16 v[128:143], v[44:47], v[24:27], v[128:143]
L_upskip_14:
    ds_read_b64_tr_b16 v[44:45], v13 offset:3072
    ds_read_b64_tr_b16 v[46:47], v13 offset:3840
    s_waitcnt lgkmcnt(4)
    v_mfma_f32_32x32x16_bf16 v[48:63], v[36:39], v[28:31], v[48:63]
    s_mov_b32 m0, s64
    s_add_u32 s46, s66, 44032
    buffer_load_dwordx4 v9, s[36:39], s66 offen lds
    v_mfma_f32_32x32x16_bf16 v[64:79], v[36:39], v[32:35], v[64:79]
    s_add_u32 m0, m0, 1024
    s_nop 0
    buffer_load_dwordx4 v10, s[36:39], s66 offen lds
    ds_read_b128 v[20:23], v18 offset:0
    ds_read_b128 v[24:27], v18 offset:4096
    ds_read_b64_tr_b16 v[36:37], v12 offset:6144
    ds_read_b64_tr_b16 v[38:39], v12 offset:6912
    s_waitcnt lgkmcnt(6)
    v_mfma_f32_32x32x16_bf16 v[80:95], v[40:43], v[28:31], v[80:95]
    s_add_u32 m0, m0, 1024
    s_nop 0
    buffer_load_dwordx4 v11, s[36:39], s66 offen lds
    v_mfma_f32_32x32x16_bf16 v[96:111], v[40:43], v[32:35], v[96:111]
    s_add_u32 m0, m0, 1024
    s_nop 0
    buffer_load_dwordx4 v9, s[36:39], s46 offen lds
    ds_read_b64_tr_b16 v[40:41], v12 offset:6176
    ds_read_b64_tr_b16 v[42:43], v12 offset:6944
    s_waitcnt lgkmcnt(6)
    s_bitcmp1_b32 s56, 0
    s_cbranch_scc0 L_upskip_15
    v_mfma_f32_32x32x16_bf16 v[112:127], v[44:47], v[28:31], v[112:127]
L_upskip_15:
    s_bitcmp1_b32 s56, 1
    s_cbranch_scc0 L_upskip_16
    v_mfma_f32_32x32x16_bf16 v[128:143], v[44:47], v[32:35], v[128:143]
L_upskip_16:
    ds_read_b64_tr_b16 v[44:45], v13 offset:6144
    ds_read_b64_tr_b16 v[46:47], v13 offset:6912
    s_waitcnt lgkmcnt(4)
    v_mfma_f32_32x32x16_bf16 v[48:63], v[36:39], v[20:23], v[48:63]
    s_add_u32 m0, m0, 1024
    s_nop 0
    buffer_load_dwordx4 v10, s[36:39], s46 offen lds
    v_mfma_f32_32x32x16_bf16 v[64:79], v[36:39], v[24:27], v[64:79]
    s_add_u32 m0, m0, 1024
    s_nop 0
    buffer_load_dwordx4 v11, s[36:39], s46 offen lds
    s_add_u32 s66, s66, 176128
    s_cmp_eq_u32 s66, 1409024
    s_cselect_b32 s66, 0, s66
    s_add_u32 s64, s64, 24832
    s_cmp_eq_u32 s64, s58
    s_cselect_b32 s44, 74496, 0
    s_sub_u32 s64, s64, s44
    ds_read_b128 v[28:31], v19 offset:0
    ds_read_b128 v[32:35], v19 offset:4096
    ds_read_b64_tr_b16 v[36:37], v12 offset:9216
    ds_read_b64_tr_b16 v[38:39], v12 offset:9984
    s_waitcnt lgkmcnt(6)
    v_mfma_f32_32x32x16_bf16 v[80:95], v[40:43], v[20:23], v[80:95]
    buffer_load_dwordx4 v[160:163], v1, s[40:43], s59 offen
    s_add_u32 s59, s59, 131072
    v_mfma_f32_32x32x16_bf16 v[96:111], v[40:43], v[24:27], v[96:111]
    buffer_load_dwordx4 v[160:163], v1, s[40:43], s59 offen
    s_add_u32 s59, s59, 131072
    buffer_load_dwordx4 v[160:163], v1, s[40:43], s59 offen
    s_add_u32 s59, s59, 131072
    ds_read_b64_tr_b16 v[40:41], v12 offset:9248
    ds_read_b64_tr_b16 v[42:43], v12 offset:10016
    s_waitcnt lgkmcnt(6)
    s_bitcmp1_b32 s56, 0
    s_cbranch_scc0 L_upskip_17
    v_mfma_f32_32x32x16_bf16 v[112:127], v[44:47], v[20:23], v[112:127]
L_upskip_17:
    s_bitcmp1_b32 s56, 1
    s_cbranch_scc0 L_upskip_18
    v_mfma_f32_32x32x16_bf16 v[128:143], v[44:47], v[24:27], v[128:143]
L_upskip_18:
    ds_read_b64_tr_b16 v[44:45], v13 offset:9216
    ds_read_b64_tr_b16 v[46:47], v13 offset:9984
    s_waitcnt lgkmcnt(4)
    v_mfma_f32_32x32x16_bf16 v[48:63], v[36:39], v[28:31], v[48:63]
    v_mfma_f32_32x32x16_bf16 v[64:79], v[36:39], v[32:35], v[64:79]
    s_cmp_eq_u32 s53, 7
    s_cbranch_scc1 L_up_last
    s_waitcnt vmcnt(9) lgkmcnt(0)
    s_add_u32 s67, s67, 4
    s_mov_b64 exec, 1
    ds_add_u32 v2, v3 offset:8
    s_mov_b64 exec, -1
    v_mfma_f32_32x32x16_bf16 v[80:95], v[40:43], v[28:31], v[80:95]
    v_mfma_f32_32x32x16_bf16 v[96:111], v[40:43], v[32:35], v[96:111]
    s_setprio 2
    v_add_u32 v16, s49, v16
    v_add_u32 v17, s49, v17
    v_add_u32 v18, s49, v18
    v_add_u32 v19, s49, v19
    v_add_u32 v12, s50, v12
    v_add_u32 v13, s50, v13
    s_mov_b32 s68, 0
L_upb_spin:
    ds_read_b32 v4, v2 offset:8
    s_add_u32 s68, s68, 1
    s_waitcnt lgkmcnt(0)
    v_cmp_gt_u32 vcc, s67, v4
    s_cmp_gt_u32 s68, 2000000
    s_cbranch_scc1 L_upb_ok
    s_cbranch_vccz L_upb_ok
    s_sleep 1
    s_branch L_upb_spin
L_upb_ok:
    s_setprio 0
    ds_read_b128 v[20:23], v16 offset:0
    ds_read_b128 v[24:27], v16 offset:4096
    ds_read_b64_tr_b16 v[36:37], v12 offset:0
    ds_read_b64_tr_b16 v[38:39], v12 offset:768
    ds_read_b64_tr_b16 v[40:41], v12 offset:32
    ds_read_b64_tr_b16 v[42:43], v12 offset:800
    s_bitcmp1_b32 s56, 0
    s_cbranch_scc0 L_upskip_19
    v_mfma_f32_32x32x16_bf16 v[112:127], v[44:47], v[28:31], v[112:127]
L_upskip_19:
    s_bitcmp1_b32 s56, 1
    s_cbranch_scc0 L_upskip_20
    v_mfma_f32_32x32x16_bf16 v[128:143], v[44:47], v[32:35], v[128:143]
L_upskip_20:
    ds_read_b64_tr_b16 v[44:45], v13 offset:0
    ds_read_b64_tr_b16 v[46:47], v13 offset:768
    s_sub_u32 s49, 0, s49
    s_add_u32 s53, s53, 1
    s_bitcmp1_b32 0x12, s53
    s_mov_b32 s44, 4294917632
    s_cselect_b32 s50, s44, 24832
    s_cmp_eq_u32 s53, 7
    s_cselect_b32 s34, 0, s34
    s_cmp_eq_u32 s53, 6
    s_cselect_b32 s38, 0, s38
    s_cmp_eq_u32 s53, 2
    s_cselect_b32 s42, 1409024, s42
    s_cselect_b32 s59, s54, s59
    s_and_b32 s44, s9, 0xffff
    s_cmp_eq_u32 s53, 6
    s_cselect_b32 s40, s8, s40
    s_cselect_b32 s41, s44, s41
    s_cselect_b32 s42, 524288, s42
    s_cselect_b32 s59, s54, s59
    s_branch L_up_loop
L_up_last:
    s_waitcnt lgkmcnt(0)
    v_mfma_f32_32x32x16_bf16 v[80:95], v[40:43], v[28:31], v[80:95]
    v_mfma_f32_32x32x16_bf16 v[96:111], v[40:43], v[32:35], v[96:111]
    s_bitcmp1_b32 s56, 0
    s_cbranch_scc0 L_upskip_21
    v_mfma_f32_32x32x16_bf16 v[112:127], v[44:47], v[28:31], v[112:127]
L_upskip_21:
    s_bitcmp1_b32 s56, 1
    s_cbranch_scc0 L_upskip_22
    v_mfma_f32_32x32x16_bf16 v[128:143], v[44:47], v[32:35], v[128:143]
L_upskip_22:
    s_setprio 2
    s_lshl_b32 s44, s51, 2
    s_and_b32 s45, s48, 1
    s_lshl_b32 s45, s45, 1
    s_add_u32 s44, s44, s45
    s_mul_i32 s44, s44, 86
    s_add_u32 s44, s44, s55
    s_and_b32 s45, s52, 255
    s_add_u32 s44, s44, s45
    s_lshl_b32 s44, s44, 10
    s_add_u32 s44, s44, 8388608
    s_lshr_b32 s46, s52, 8
    s_sub_u32 s52, s46, s45
    s_lshl_b32 s52, s52, 10
    s_add_u32 s45, s44, 88064
    s_mov_b32 s46, 0xbfb8aa3b
    s_mov_b32 s47, s46
    v_pk_mul_f32 v[48:49], v[48:49], s[46:47]
    v_pk_mul_f32 v[50:51], v[50:51], s[46:47]
    v_pk_mul_f32 v[52:53], v[52:53], s[46:47]
    v_pk_mul_f32 v[54:55], v[54:55], s[46:47]
    v_exp_f32 v48, v48
    v_exp_f32 v49, v49
    v_exp_f32 v50, v50
    v_exp_f32 v51, v51
    v_exp_f32 v52, v52
    v_exp_f32 v53, v53
    v_exp_f32 v54, v54
    v_exp_f32 v55, v55
    v_pk_add_f32 v[48:49], v[48:49], 1.0 op_sel_hi:[1,0]
    v_pk_add_f32 v[50:51], v[50:51], 1.0 op_sel_hi:[1,0]
    v_pk_add_f32 v[52:53], v[52:53], 1.0 op_sel_hi:[1,0]
    v_pk_add_f32 v[54:55], v[54:55], 1.0 op_sel_hi:[1,0]
    v_rcp_f32 v48, v48
    v_rcp_f32 v49, v49
    v_rcp_f32 v50, v50
    v_rcp_f32 v51, v51
    v_rcp_f32 v52, v52
    v_rcp_f32 v53, v53
    v_rcp_f32 v54, v54
    v_rcp_f32 v55, v55
    v_pk_mul_f32 v[48:49], v[48:49], v[56:57]
    v_pk_mul_f32 v[50:51], v[50:51], v[58:59]
    v_pk_mul_f32 v[52:53], v[52:53], v[60:61]
    v_pk_mul_f32 v[54:55], v[54:55], v[62:63]
    v_cvt_pk_bf16_f32 v20, v48, v49
    v_cvt_pk_bf16_f32 v21, v50, v51
    v_cvt_pk_bf16_f32 v22, v52, v53
    v_cvt_pk_bf16_f32 v23, v54, v55
    buffer_store_dwordx4 v[20:23], v1, s[28:31], s44 offen offset:0 sc1
    v_pk_mul_f32 v[64:65], v[64:65], s[46:47]
    v_pk_mul_f32 v[66:67], v[66:67], s[46:47]
    v_pk_mul_f32 v[68:69], v[68:69], s[46:47]
    v_pk_mul_f32 v[70:71], v[70:71], s[46:47]
    v_exp_f32 v64, v64
    v_exp_f32 v65, v65
    v_exp_f32 v66, v66
    v_exp_f32 v67, v67
    v_exp_f32 v68, v68
    v_exp_f32 v69, v69
    v_exp_f32 v70, v70
    v_exp_f32 v71, v71
    v_pk_add_f32 v[64:65], v[64:65], 1.0 op_sel_hi:[1,0]
    v_pk_add_f32 v[66:67], v[66:67], 1.0 op_sel_hi:[1,0]
    v_pk_add_f32 v[68:69], v[68:69], 1.0 op_sel_hi:[1,0]
    v_pk_add_f32 v[70:71], v[70:71], 1.0 op_sel_hi:[1,0]
    v_rcp_f32 v64, v64
    v_rcp_f32 v65, v65
    v_rcp_f32 v66, v66
    v_rcp_f32 v67, v67
    v_rcp_f32 v68, v68
    v_rcp_f32 v69, v69
    v_rcp_f32 v70, v70
    v_rcp_f32 v71, v71
    v_pk_mul_f32 v[64:65], v[64:65], v[72:73]
    v_pk_mul_f32 v[66:67], v[66:67], v[74:75]
    v_pk_mul_f32 v[68:69], v[68:69], v[76:77]
    v_pk_mul_f32 v[70:71], v[70:71], v[78:79]
    v_cvt_pk_bf16_f32 v24, v64, v65
    v_cvt_pk_bf16_f32 v25, v66, v67
    v_cvt_pk_bf16_f32 v26, v68, v69
    v_cvt_pk_bf16_f32 v27, v70, v71
    buffer_store_dwordx4 v[24:27], v1, s[28:31], s45 offen offset:0 sc1
    v_pk_mul_f32 v[80:81], v[80:81], s[46:47]
    v_pk_mul_f32 v[82:83], v[82:83], s[46:47]
    v_pk_mul_f32 v[84:85], v[84:85], s[46:47]
    v_pk_mul_f32 v[86:87], v[86:87], s[46:47]
    v_exp_f32 v80, v80
    v_exp_f32 v81, v81
    v_exp_f32 v82, v82
    v_exp_f32 v83, v83
    v_exp_f32 v84, v84
    v_exp_f32 v85, v85
    v_exp_f32 v86, v86
    v_exp_f32 v87, v87
    v_pk_add_f32 v[80:81], v[80:81], 1.0 op_sel_hi:[1,0]
    v_pk_add_f32 v[82:83], v[82:83], 1.0 op_sel_hi:[1,0]
    v_pk_add_f32 v[84:85], v[84:85], 1.0 op_sel_hi:[1,0]
    v_pk_add_f32 v[86:87], v[86:87], 1.0 op_sel_hi:[1,0]
    v_rcp_f32 v80, v80
    v_rcp_f32 v81, v81
    v_rcp_f32 v82, v82
    v_rcp_f32 v83, v83
    v_rcp_f32 v84, v84
    v_rcp_f32 v85, v85
    v_rcp_f32 v86, v86
    v_rcp_f32 v87, v87
    v_pk_mul_f32 v[80:81], v[80:81], v[88:89]
    v_pk_mul_f32 v[82:83], v[82:83], v[90:91]
    v_pk_mul_f32 v[84:85], v[84:85], v[92:93]
    v_pk_mul_f32 v[86:87], v[86:87], v[94:95]
    v_cvt_pk_bf16_f32 v28, v80, v81
    v_cvt_pk_bf16_f32 v29, v82, v83
    v_cvt_pk_bf16_f32 v30, v84, v85
    v_cvt_pk_bf16_f32 v31, v86, v87
    buffer_store_dwordx4 v[28:31], v1, s[28:31], s44 offen offset:1024 sc1
    v_pk_mul_f32 v[96:97], v[96:97], s[46:47]
    v_pk_mul_f32 v[98:99], v[98:99], s[46:47]
    v_pk_mul_f32 v[100:101], v[100:101], s[46:47]
    v_pk_mul_f32 v[102:103], v[102:103], s[46:47]
    v_exp_f32 v96, v96
    v_exp_f32 v97, v97
    v_exp_f32 v98, v98
    v_exp_f32 v99, v99
    v_exp_f32 v100, v100
    v_exp_f32 v101, v101
    v_exp_f32 v102, v102
    v_exp_f32 v103, v103
    v_pk_add_f32 v[96:97], v[96:97], 1.0 op_sel_hi:[1,0]
    v_pk_add_f32 v[98:99], v[98:99], 1.0 op_sel_hi:[1,0]
    v_pk_add_f32 v[100:101], v[100:101], 1.0 op_sel_hi:[1,0]
    v_pk_add_f32 v[102:103], v[102:103], 1.0 op_sel_hi:[1,0]
    v_rcp_f32 v96, v96
    v_rcp_f32 v97, v97
    v_rcp_f32 v98, v98
    v_rcp_f32 v99, v99
    v_rcp_f32 v100, v100
    v_rcp_f32 v101, v101
    v_rcp_f32 v102, v102
    v_rcp_f32 v103, v103
    v_pk_mul_f32 v[96:97], v[96:97], v[104:105]
    v_pk_mul_f32 v[98:99], v[98:99], v[106:107]
    v_pk_mul_f32 v[100:101], v[100:101], v[108:109]
    v_pk_mul_f32 v[102:103], v[102:103], v[110:111]
    v_cvt_pk_bf16_f32 v32, v96, v97
    v_cvt_pk_bf16_f32 v33, v98, v99
    v_cvt_pk_bf16_f32 v34, v100, v101
    v_cvt_pk_bf16_f32 v35, v102, v103
    buffer_store_dwordx4 v[32:35], v1, s[28:31], s45 offen offset:1024 sc1
    s_add_u32 s44, s44, s52
    s_add_u32 s45, s45, s52
    s_bitcmp1_b32 s56, 0
    s_cbranch_scc0 L_up_e1
    v_pk_mul_f32 v[112:113], v[112:113], s[46:47]
    v_pk_mul_f32 v[114:115], v[114:115], s[46:47]
    v_pk_mul_f32 v[116:117], v[116:117], s[46:47]
    v_pk_mul_f32 v[118:119], v[118:119], s[46:47]
    v_exp_f32 v112, v112
    v_exp_f32 v113, v113
    v_exp_f32 v114, v114
    v_exp_f32 v115, v115
    v_exp_f32 v116, v116
    v_exp_f32 v117, v117
    v_exp_f32 v118, v118
    v_exp_f32 v119, v119
    v_pk_add_f32 v[112:113], v[112:113], 1.0 op_sel_hi:[1,0]
    v_pk_add_f32 v[114:115], v[114:115], 1.0 op_sel_hi:[1,0]
    v_pk_add_f32 v[116:117], v[116:117], 1.0 op_sel_hi:[1,0]
    v_pk_add_f32 v[118:119], v[118:119], 1.0 op_sel_hi:[1,0]
    v_rcp_f32 v112, v112
    v_rcp_f32 v113, v113
    v_rcp_f32 v114, v114
    v_rcp_f32 v115, v115
    v_rcp_f32 v116, v116
    v_rcp_f32 v117, v117
    v_rcp_f32 v118, v118
    v_rcp_f32 v119, v119
    v_pk_mul_f32 v[112:113], v[112:113], v[120:121]
    v_pk_mul_f32 v[114:115], v[114:115], v[122:123]
    v_pk_mul_f32 v[116:117], v[116:117], v[124:125]
    v_pk_mul_f32 v[118:119], v[118:119], v[126:127]
    v_cvt_pk_bf16_f32 v20, v112, v113
    v_cvt_pk_bf16_f32 v21, v114, v115
    v_cvt_pk_bf16_f32 v22, v116, v117
    v_cvt_pk_bf16_f32 v23, v118, v119
    buffer_store_dwordx4 v[20:23], v1, s[28:31], s44 offen offset:0 sc1
L_up_e1:
    s_bitcmp1_b32 s56, 1
    s_cbranch_scc0 L_up_done
    v_pk_mul_f32 v[128:129], v[128:129], s[46:47]
    v_pk_mul_f32 v[130:131], v[130:131], s[46:47]
    v_pk_mul_f32 v[132:133], v[132:133], s[46:47]
    v_pk_mul_f32 v[134:135], v[134:135], s[46:47]
    v_exp_f32 v128, v128
    v_exp_f32 v129, v129
    v_exp_f32 v130, v130
    v_exp_f32 v131, v131
    v_exp_f32 v132, v132
    v_exp_f32 v133, v133
    v_exp_f32 v134, v134
    v_exp_f32 v135, v135
    v_pk_add_f32 v[128:129], v[128:129], 1.0 op_sel_hi:[1,0]
    v_pk_add_f32 v[130:131], v[130:131], 1.0 op_sel_hi:[1,0]
    v_pk_add_f32 v[132:133], v[132:133], 1.0 op_sel_hi:[1,0]
    v_pk_add_f32 v[134:135], v[134:135], 1.0 op_sel_hi:[1,0]
    v_rcp_f32 v128, v128
    v_rcp_f32 v129, v129
    v_rcp_f32 v130, v130
    v_rcp_f32 v131, v131
    v_rcp_f32 v132, v132
    v_rcp_f32 v133, v133
    v_rcp_f32 v134, v134
    v_rcp_f32 v135, v135
    v_pk_mul_f32 v[128:129], v[128:129], v[136:137]
    v_pk_mul_f32 v[130:131], v[130:131], v[138:139]
    v_pk_mul_f32 v[132:133], v[132:133], v[140:141]
    v_pk_mul_f32 v[134:135], v[134:135], v[142:143]
    v_cvt_pk_bf16_f32 v24, v128, v129
    v_cvt_pk_bf16_f32 v25, v130, v131
    v_cvt_pk_bf16_f32 v26, v132, v133
    v_cvt_pk_bf16_f32 v27, v134, v135
    buffer_store_dwordx4 v[24:27], v1, s[28:31], s45 offen offset:0 sc1
L_up_done:
    s_lshl_b32 s44, s51, 2
    s_add_u32 s44, s44, s48
    s_lshl_b32 s44, s44, 7
    s_add_u32 s44, s44, 14753792
    s_waitcnt vmcnt(0)
    s_mov_b64 exec, 1
    buffer_atomic_add v3, off, s[28:31], s44 sc1
    s_mov_b64 exec, -1
    s_add_u32 s67, s67, 4
    s_mov_b64 exec, 1
    ds_add_u32 v2, v3 offset:8
    s_mov_b64 exec, -1
    s_mov_b32 s68, 0
L_fb_23_spin:
    ds_read_b32 v4, v2 offset:8
    s_add_u32 s68, s68, 1
    s_waitcnt lgkmcnt(0)
    v_cmp_gt_u32 vcc, s67, v4
    s_cmp_gt_u32 s68, 2000000
    s_cbranch_scc1 L_fb_23_ok
    s_cbranch_vccz L_fb_23_ok
    s_sleep 2
    s_branch L_fb_23_spin
L_fb_23_ok:
    ds_read_b32 v7, v2 offset:0
    s_mov_b32 s32, s8
    s_and_b32 s33, s9, 0xffff
    s_mov_b32 s34, 524288
    s_mov_b32 s35, 0x20000
    s_lshl_b32 s51, s48, 17
    s_mov_b32 m0, s62
    s_mov_b32 s52, 14
L_wo_ld:
    buffer_load_dwordx4 v14, s[32:35], s51 offen lds
    s_add_u32 m0, m0, 1024
    s_add_u32 s51, s51, 8192
    s_sub_u32 s52, s52, 1
    s_cmp_lg_u32 s52, 0
    s_cbranch_scc1 L_wo_ld
    s_mov_b32 s32, s16
    s_and_b32 s33, s17, 0xffff
    s_mov_b32 s34, 1409024
    s_mov_b32 s35, 0x20000
    s_mul_i32 s56, s48, 6144
    s_add_u32 s56, s56, 131072
    v_add_u32 v11, s56, v15
    v_xor_b32 v12, 64, v11
    v_add_u32 v160, s62, v15
    v_xor_b32 v161, 64, v160
    s_lshl_b32 s51, s48, 14
    s_lshl_b32 s44, s60, 1
    s_and_b32 s45, s48, 1
    s_add_u32 s53, s44, s45
    s_xor_b32 s47, s53, 1
    s_mul_i32 s49, s53, 86
    s_add_u32 s49, s49, s48
    s_lshl_b32 s49, s49, 10
    s_add_u32 s49, s49, 8388608
    s_mul_i32 s50, s47, 86
    s_add_u32 s50, s50, s48
    s_lshl_b32 s50, s50, 10
    s_add_u32 s50, s50, 8388608
    s_lshl_b32 s44, s61, 1
    s_lshr_b32 s45, s48, 1
    s_add_u32 s54, s44, s45
    v_and_b32 v4, 31, v0
    v_lshrrev_b32 v5, 5, v0
    v_lshlrev_b32 v5, 4, v5
    v_lshl_add_u32 v10, v4, 10, v5
    s_waitcnt lgkmcnt(0)
    v_readfirstlane_b32 s27, v7
    v_lshlrev_b32 v5, 3, v4
    s_lshl_b32 s44, s53, 8
    s_add_u32 s44, s44, 14680064
    s_mov_b32 s68, 0
L_g_poll:
    buffer_load_dwordx2 v[8:9], v5, s[28:31], s44 offen sc1
    s_add_u32 s68, s68, 1
    s_waitcnt vmcnt(0)
    v_cmp_ne_u32 vcc, s27, v9
    s_cmp_gt_u32 s68, 200000
    s_cbranch_scc1 L_g_got
    s_cbranch_vccz L_g_got
    s_sleep 8
    s_branch L_g_poll
L_g_got:
    v_sub_f32 v9, 1.0, v8
    s_cmp_eq_u32 s48, 0
    s_cbranch_scc0 L_dn_nopoll
    s_lshr_b32 s44, s60, 1
    s_lshl_b32 s44, s44, 2
    s_and_b32 s45, s60, 1
    s_add_u32 s44, s44, s45
    s_lshl_b32 s44, s44, 7
    s_add_u32 s44, s44, 14753792
    v_and_b32 v6, 1, v0
    v_lshlrev_b32 v6, 8, v6
    s_mov_b32 s68, 0
    s_mov_b64 exec, 3
    v_mov_b32 v5, 0
    buffer_atomic_or v5, v6, s[28:31], s44 offen sc0 sc1
L_dn_poll:
    s_add_u32 s68, s68, 1
    s_waitcnt vmcnt(0)
    v_cmp_gt_u32 vcc, 16, v5
    s_cmp_gt_u32 s68, 200000
    s_cbranch_scc1 L_dn_got
    s_cbranch_vccz L_dn_got
    s_sleep 8
    v_mov_b32 v5, 0
    buffer_atomic_or v5, v6, s[28:31], s44 offen sc0 sc1
    s_branch L_dn_poll
L_dn_got:
    s_mov_b64 exec, -1
L_dn_nopoll:
    s_add_u32 s67, s67, 4
    s_mov_b64 exec, 1
    ds_add_u32 v2, v3 offset:8
    s_mov_b64 exec, -1
    s_mov_b32 s68, 0
L_fb_24_spin:
    ds_read_b32 v5, v2 offset:8
    s_add_u32 s68, s68, 1
    s_waitcnt lgkmcnt(0)
    v_cmp_gt_u32 vcc, s67, v5
    s_cmp_gt_u32 s68, 2000000
    s_cbranch_scc1 L_fb_24_ok
    s_cbranch_vccz L_fb_24_ok
    s_sleep 2
    s_branch L_fb_24_spin
L_fb_24_ok:
    s_sub_u32 s50, s50, s49
    s_mov_b32 s46, s51
    s_mov_b32 s47, s49
    s_add_u32 s57, s46, 1376256
    s_add_u32 s58, s47, 86016
    s_and_b32 s44, s69, 3
    s_mul_i32 s44, s44, 5
    s_mul_i32 s45, s61, 21
    s_lshr_b32 s45, s45, 3
    s_add_u32 s44, s44, s45
    s_cmp_ge_u32 s44, 21
    s_cselect_b32 s45, 21, 0
    s_sub_u32 s52, s44, s45
    s_mov_b32 s51, s57
    s_cmp_lt_u32 s48, 2
    s_cselect_b32 s49, s58, s47
    s_add_u32 m0, s56, 0
    s_add_u32 s44, s51, 8192
    buffer_load_dwordx4 v14, s[32:35], s51 offen lds
    s_add_u32 m0, m0, 1024
    s_add_u32 s51, s51, 65536
    buffer_load_dwordx4 v14, s[32:35], s44 offen lds
    s_cmp_eq_u32 s51, s57
    s_cselect_b32 s51, s46, s51
    s_lshl_b32 s44, s52, 16
    s_add_u32 s51, s46, s44
    s_add_u32 m0, s56, 2048
    s_add_u32 s44, s51, 8192
    buffer_load_dwordx4 v14, s[32:35], s51 offen lds
    s_add_u32 m0, m0, 1024
    s_add_u32 s51, s51, 65536
    buffer_load_dwordx4 v14, s[32:35], s44 offen lds
    s_cmp_eq_u32 s51, s57
    s_cselect_b32 s51, s46, s51
    s_add_u32 s45, s49, s50
    buffer_load_dwordx4 v[80:83], v1, s[28:31], s49 offen sc1
    s_add_u32 s49, s49, 4096
    buffer_load_dwordx4 v[84:87], v1, s[28:31], s45 offen sc1
    s_cmp_eq_u32 s49, s58
    s_cselect_b32 s49, s47, s49
    s_lshl_b32 s44, s52, 12
    s_add_u32 s49, s47, s44
    s_add_u32 m0, s56, 4096
    s_add_u32 s44, s51, 8192
    buffer_load_dwordx4 v14, s[32:35], s51 offen lds
    s_add_u32 m0, m0, 1024
    s_add_u32 s51, s51, 65536
    buffer_load_dwordx4 v14, s[32:35], s44 offen lds
    s_cmp_eq_u32 s51, s57
    s_cselect_b32 s51, s46, s51
    s_add_u32 s45, s49, s50
    buffer_load_dwordx4 v[88:91], v1, s[28:31], s49 offen sc1
    s_add_u32 s49, s49, 4096
    buffer_load_dwordx4 v[92:95], v1, s[28:31], s45 offen sc1
    s_cmp_eq_u32 s49, s58
    s_cselect_b32 s49, s47, s49
    s_add_u32 m0, s62, 14336
    s_add_u32 s44, s51, 8192
    buffer_load_dwordx4 v14, s[32:35], s51 offen lds
    s_add_u32 m0, m0, 1024
    s_add_u32 s51, s51, 65536
    buffer_load_dwordx4 v14, s[32:35], s44 offen lds
    s_cmp_eq_u32 s51, s57
    s_cselect_b32 s51, s46, s51
    s_add_u32 s45, s49, s50
    buffer_load_dwordx4 v[96:99], v1, s[28:31], s49 offen sc1
    s_add_u32 s49, s49, 4096
    buffer_load_dwordx4 v[100:103], v1, s[28:31], s45 offen sc1
    s_cmp_eq_u32 s49, s58
    s_cselect_b32 s49, s47, s49
    s_setprio 0
    s_waitcnt vmcnt(12)
    ds_read_b64_tr_b16 v[144:145], v11 offset:0
    ds_read_b64_tr_b16 v[146:147], v11 offset:1024
    ds_read_b64_tr_b16 v[148:149], v12 offset:0
    ds_read_b64_tr_b16 v[150:151], v12 offset:1024
    s_waitcnt vmcnt(8) lgkmcnt(0)
    v_mfma_f32_32x32x16_bf16 v[16:31], v[144:147], v[80:83], 0
    ds_read_b64_tr_b16 v[152:153], v11 offset:2048
    ds_read_b64_tr_b16 v[154:155], v11 offset:3072
    s_add_u32 m0, s56, 0
    s_add_u32 s44, s51, 8192
    buffer_load_dwordx4 v14, s[32:35], s51 offen lds
    v_mfma_f32_32x32x16_bf16 v[32:47], v[144:147], v[84:87], 0
    ds_read_b64_tr_b16 v[156:157], v12 offset:2048
    ds_read_b64_tr_b16 v[158:159], v12 offset:3072
    s_add_u32 m0, m0, 1024
    s_add_u32 s51, s51, 65536
    buffer_load_dwordx4 v14, s[32:35], s44 offen lds
    s_cmp_eq_u32 s51, s57
    s_cselect_b32 s51, s46, s51
    v_mfma_f32_32x32x16_bf16 v[48:63], v[148:151], v[80:83], 0
    s_add_u32 s45, s49, s50
    buffer_load_dwordx4 v[104:107], v1, s[28:31], s49 offen sc1
    v_mfma_f32_32x32x16_bf16 v[64:79], v[148:151], v[84:87], 0
    s_add_u32 s49, s49, 4096
    buffer_load_dwordx4 v[108:111], v1, s[28:31], s45 offen sc1
    s_cmp_eq_u32 s49, s58
    s_cselect_b32 s49, s47, s49
    s_mov_b32 s52, 4
L_dn_loop:
    s_waitcnt vmcnt(8) lgkmcnt(0)
    v_mfma_f32_32x32x16_bf16 v[16:31], v[152:155], v[88:91], v[16:31]
    ds_read_b64_tr_b16 v[144:145], v11 offset:4096
    ds_read_b64_tr_b16 v[146:147], v11 offset:5120
    s_add_u32 m0, s56, 2048
    s_add_u32 s44, s51, 8192
    buffer_load_dwordx4 v14, s[32:35], s51 offen lds
    v_mfma_f32_32x32x16_bf16 v[32:47], v[152:155], v[92:95], v[32:47]
    ds_read_b64_tr_b16 v[148:149], v12 offset:4096
    ds_read_b64_tr_b16 v[150:151], v12 offset:5120
    s_add_u32 m0, m0, 1024
    s_add_u32 s51, s51, 65536
    buffer_load_dwordx4 v14, s[32:35], s44 offen lds
    s_cmp_eq_u32 s51, s57
    s_cselect_b32 s51, s46, s51
    v_mfma_f32_32x32x16_bf16 v[48:63], v[156:159], v[88:91], v[48:63]
    s_add_u32 s45, s49, s50
    buffer_load_dwordx4 v[80:83], v1, s[28:31], s49 offen sc1
    v_mfma_f32_32x32x16_bf16 v[64:79], v[156:159], v[92:95], v[64:79]
    s_add_u32 s49, s49, 4096
    buffer_load_dwordx4 v[84:87], v1, s[28:31], s45 offen sc1
    s_cmp_eq_u32 s49, s58
    s_cselect_b32 s49, s47, s49
    s_waitcnt vmcnt(8) lgkmcnt(0)
    v_mfma_f32_32x32x16_bf16 v[16:31], v[144:147], v[96:99], v[16:31]
    ds_read_b64_tr_b16 v[152:153], v160 offset:14336
    ds_read_b64_tr_b16 v[154:155], v160 offset:15360
    s_add_u32 m0, s56, 4096
    s_add_u32 s44, s51, 8192
    buffer_load_dwordx4 v14, s[32:35], s51 offen lds
    v_mfma_f32_32x32x16_bf16 v[32:47], v[144:147], v[100:103], v[32:47]
    ds_read_b64_tr_b16 v[156:157], v161 offset:14336
    ds_read_b64_tr_b16 v[158:159], v161 offset:15360
    s_add_u32 m0, m0, 1024
    s_add_u32 s51, s51, 65536
    buffer_load_dwordx4 v14, s[32:35], s44 offen lds
    s_cmp_eq_u32 s51, s57
    s_cselect_b32 s51, s46, s51
    v_mfma_f32_32x32x16_bf16 v[48:63], v[148:151], v[96:99], v[48:63]
    s_add_u32 s45, s49, s50
    buffer_load_dwordx4 v[88:91], v1, s[28:31], s49 offen sc1
    v_mfma_f32_32x32x16_bf16 v[64:79], v[148:151], v[100:103], v[64:79]
    s_add_u32 s49, s49, 4096
    buffer_load_dwordx4 v[92:95], v1, s[28:31], s45 offen sc1
    s_cmp_eq_u32 s49, s58
    s_cselect_b32 s49, s47, s49
    s_waitcnt vmcnt(8) lgkmcnt(0)
    v_mfma_f32_32x32x16_bf16 v[16:31], v[152:155], v[104:107], v[16:31]
    ds_read_b64_tr_b16 v[144:145], v11 offset:0
    ds_read_b64_tr_b16 v[146:147], v11 offset:1024
    s_add_u32 m0, s62, 14336
    s_add_u32 s44, s51, 8192
    buffer_load_dwordx4 v14, s[32:35], s51 offen lds
    v_mfma_f32_32x32x16_bf16 v[32:47], v[152:155], v[108:111], v[32:47]
    ds_read_b64_tr_b16 v[148:149], v12 offset:0
    ds_read_b64_tr_b16 v[150:151], v12 offset:1024
    s_add_u32 m0, m0, 1024
    s_add_u32 s51, s51, 65536
    buffer_load_dwordx4 v14, s[32:35], s44 offen lds
    s_cmp_eq_u32 s51, s57
    s_cselect_b32 s51, s46, s51
    v_mfma_f32_32x32x16_bf16 v[48:63], v[156:159], v[104:107], v[48:63]
    s_add_u32 s45, s49, s50
    buffer_load_dwordx4 v[96:99], v1, s[28:31], s49 offen sc1
    v_mfma_f32_32x32x16_bf16 v[64:79], v[156:159], v[108:111], v[64:79]
    s_add_u32 s49, s49, 4096
    buffer_load_dwordx4 v[100:103], v1, s[28:31], s45 offen sc1
    s_cmp_eq_u32 s49, s58
    s_cselect_b32 s49, s47, s49
    s_waitcnt vmcnt(8) lgkmcnt(0)
    v_mfma_f32_32x32x16_bf16 v[16:31], v[144:147], v[80:83], v[16:31]
    ds_read_b64_tr_b16 v[152:153], v11 offset:2048
    ds_read_b64_tr_b16 v[154:155], v11 offset:3072
    s_add_u32 m0, s56, 0
    s_add_u32 s44, s51, 8192
    buffer_load_dwordx4 v14, s[32:35], s51 offen lds
    v_mfma_f32_32x32x16_bf16 v[32:47], v[144:147], v[84:87], v[32:47]
    ds_read_b64_tr_b16 v[156:157], v12 offset:2048
    ds_read_b64_tr_b16 v[158:159], v12 offset:3072
    s_add_u32 m0, m0, 1024
    s_add_u32 s51, s51, 65536
    buffer_load_dwordx4 v14, s[32:35], s44 offen lds
    s_cmp_eq_u32 s51, s57
    s_cselect_b32 s51, s46, s51
    v_mfma_f32_32x32x16_bf16 v[48:63], v[148:151], v[80:83], v[48:63]
    s_add_u32 s45, s49, s50
    buffer_load_dwordx4 v[104:107], v1, s[28:31], s49 offen sc1
    v_mfma_f32_32x32x16_bf16 v[64:79], v[148:151], v[84:87], v[64:79]
    s_add_u32 s49, s49, 4096
    buffer_load_dwordx4 v[108:111], v1, s[28:31], s45 offen sc1
    s_cmp_eq_u32 s49, s58
    s_cselect_b32 s49, s47, s49
    s_sub_u32 s52, s52, 1
    s_cmp_lg_u32 s52, 0
    s_cbranch_scc1 L_dn_loop
    s_waitcnt vmcnt(8) lgkmcnt(0)
    v_mfma_f32_32x32x16_bf16 v[16:31], v[152:155], v[88:91], v[16:31]
    ds_read_b64_tr_b16 v[144:145], v11 offset:4096
    ds_read_b64_tr_b16 v[146:147], v11 offset:5120
    s_add_u32 m0, s56, 2048
    s_add_u32 s44, s51, 8192
    buffer_load_dwordx4 v14, s[32:35], s51 offen lds
    v_mfma_f32_32x32x16_bf16 v[32:47], v[152:155], v[92:95], v[32:47]
    ds_read_b64_tr_b16 v[148:149], v12 offset:4096
    ds_read_b64_tr_b16 v[150:151], v12 offset:5120
    s_add_u32 m0, m0, 1024
    s_add_u32 s51, s51, 65536
    buffer_load_dwordx4 v14, s[32:35], s44 offen lds
    s_cmp_eq_u32 s51, s57
    s_cselect_b32 s51, s46, s51
    v_mfma_f32_32x32x16_bf16 v[48:63], v[156:159], v[88:91], v[48:63]
    s_add_u32 s45, s49, s50
    buffer_load_dwordx4 v[80:83], v1, s[28:31], s49 offen sc1
    v_mfma_f32_32x32x16_bf16 v[64:79], v[156:159], v[92:95], v[64:79]
    s_add_u32 s49, s49, 4096
    buffer_load_dwordx4 v[84:87], v1, s[28:31], s45 offen sc1
    s_cmp_eq_u32 s49, s58
    s_cselect_b32 s49, s47, s49
    s_waitcnt vmcnt(8) lgkmcnt(0)
    v_mfma_f32_32x32x16_bf16 v[16:31], v[144:147], v[96:99], v[16:31]
    ds_read_b64_tr_b16 v[152:153], v160 offset:14336
    ds_read_b64_tr_b16 v[154:155], v160 offset:15360
    v_mfma_f32_32x32x16_bf16 v[32:47], v[144:147], v[100:103], v[32:47]
    ds_read_b64_tr_b16 v[156:157], v161 offset:14336
    ds_read_b64_tr_b16 v[158:159], v161 offset:15360
    v_mfma_f32_32x32x16_bf16 v[48:63], v[148:151], v[96:99], v[48:63]
    s_add_u32 s45, s49, s50
    buffer_load_dwordx4 v[88:91], v1, s[28:31], s49 offen sc1
    v_mfma_f32_32x32x16_bf16 v[64:79], v[148:151], v[100:103], v[64:79]
    s_add_u32 s49, s49, 4096
    buffer_load_dwordx4 v[92:95], v1, s[28:31], s45 offen sc1
    s_cmp_eq_u32 s49, s58
    s_cselect_b32 s49, s47, s49
    s_waitcnt vmcnt(6) lgkmcnt(0)
    v_mfma_f32_32x32x16_bf16 v[16:31], v[152:155], v[104:107], v[16:31]
    ds_read_b64_tr_b16 v[144:145], v11 offset:0
    ds_read_b64_tr_b16 v[146:147], v11 offset:1024
    s_mov_b32 s32, s8
    s_and_b32 s33, s9, 0xffff
    s_mov_b32 s34, 524288
    s_lshl_b32 s44, s48, 17
    s_add_u32 s44, s44, 114688
    v_mfma_f32_32x32x16_bf16 v[32:47], v[152:155], v[108:111], v[32:47]
    ds_read_b64_tr_b16 v[148:149], v12 offset:0
    ds_read_b64_tr_b16 v[150:151], v12 offset:1024
    s_add_u32 m0, s62, 14336
    s_add_u32 s45, s44, 8192
    buffer_load_dwordx4 v14, s[32:35], s44 offen lds
    v_mfma_f32_32x32x16_bf16 v[48:63], v[156:159], v[104:107], v[48:63]
    s_add_u32 m0, m0, 1024
    s_nop 0
    buffer_load_dwordx4 v14, s[32:35], s45 offen lds
    v_mfma_f32_32x32x16_bf16 v[64:79], v[156:159], v[108:111], v[64:79]
    s_waitcnt vmcnt(4) lgkmcnt(0)
    v_mfma_f32_32x32x16_bf16 v[16:31], v[144:147], v[80:83], v[16:31]
    ds_read_b64_tr_b16 v[152:153], v11 offset:2048
    ds_read_b64_tr_b16 v[154:155], v11 offset:3072
    s_mov_b32 s36, s20
    s_and_b32 s37, s21, 0xffff
    s_mov_b32 s38, 2097152
    s_mov_b32 s39, 0x20000
    v_mfma_f32_32x32x16_bf16 v[32:47], v[144:147], v[84:87], v[32:47]
    ds_read_b64_tr_b16 v[156:157], v12 offset:2048
    ds_read_b64_tr_b16 v[158:159], v12 offset:3072
    s_lshr_b32 s46, s48, 1
    s_lshl_b32 s44, s53, 15
    s_lshl_b32 s45, s46, 14
    s_add_u32 s45, s44, s45
    s_add_u32 s49, s45, 6291456
    v_mfma_f32_32x32x16_bf16 v[48:63], v[148:151], v[80:83], v[48:63]
    s_lshl_b32 s45, s54, 6
    s_add_u32 s50, s44, s45
    s_lshl_b32 s44, s53, 1
    s_add_u32 s44, s44, s46
    v_mfma_f32_32x32x16_bf16 v[64:79], v[148:151], v[84:87], v[64:79]
    s_lshl_b32 s44, s44, 7
    s_add_u32 s51, s44, 14761984
    s_waitcnt vmcnt(2) lgkmcnt(0)
    v_mfma_f32_32x32x16_bf16 v[16:31], v[152:155], v[88:91], v[16:31]
    v_mfma_f32_32x32x16_bf16 v[32:47], v[152:155], v[92:95], v[32:47]
    v_mfma_f32_32x32x16_bf16 v[48:63], v[156:159], v[88:91], v[48:63]
    v_mfma_f32_32x32x16_bf16 v[64:79], v[156:159], v[92:95], v[64:79]
    s_setprio 2
    s_waitcnt vmcnt(0)
    s_barrier
    s_mov_b64 exec, 1
    v_mov_b32 v5, 0
    buffer_atomic_or v5, off, s[28:31], s51 sc0 sc1
    s_mov_b64 exec, -1
    s_lshl_b32 s44, s46, 15
    s_add_u32 s44, s44, 65536
    v_add_u32 v11, s44, v15
    v_xor_b32 v12, 64, v11
    s_lshl_b32 s44, s48, 13
    v_add_u32 v4, s44, v1
    v_xor_b32 v6, 8192, v4
    v_xor_b32 v7, 16384, v4
    ds_write_b128 v4, v[32:35] offset:0
    ds_write_b128 v4, v[36:39] offset:1024
    ds_write_b128 v4, v[40:43] offset:2048
    ds_write_b128 v4, v[44:47] offset:3072
    ds_write_b128 v4, v[64:67] offset:4096
    ds_write_b128 v4, v[68:71] offset:5120
    ds_write_b128 v4, v[72:75] offset:6144
    ds_write_b128 v4, v[76:79] offset:7168
    s_waitcnt lgkmcnt(0)
    s_barrier
    ds_read_b128 v[32:35], v6 offset:0
    ds_read_b128 v[36:39], v6 offset:1024
    ds_read_b128 v[40:43], v6 offset:2048
    ds_read_b128 v[44:47], v6 offset:3072
    ds_read_b128 v[64:67], v6 offset:4096
    ds_read_b128 v[68:71], v6 offset:5120
    ds_read_b128 v[72:75], v6 offset:6144
    ds_read_b128 v[76:79], v6 offset:7168
    ds_read_b64_tr_b16 v[148:149], v12 offset:0
    ds_read_b64_tr_b16 v[150:151], v12 offset:1024
    ds_read_b64_tr_b16 v[144:145], v11 offset:0
    ds_read_b64_tr_b16 v[146:147], v11 offset:1024
    s_mov_b32 s68, 0
    s_mov_b64 exec, 1
L_tl_poll:
    s_add_u32 s68, s68, 1
    s_waitcnt vmcnt(0)
    v_cmp_gt_u32 vcc, 16, v5
    s_cmp_gt_u32 s68, 200000
    s_cbranch_scc1 L_tl_got
    s_cbranch_vccz L_tl_got
    s_sleep 1
    v_mov_b32 v5, 0
    buffer_atomic_or v5, off, s[28:31], s51 sc0 sc1
    s_branch L_tl_poll
L_tl_got:
    s_mov_b64 exec, -1
    buffer_load_dwordx4 v[80:83], v1, s[28:31], s49 offen offset:0 sc1
    buffer_load_dwordx4 v[84:87], v1, s[28:31], s49 offen offset:1024 sc1
    buffer_load_dwordx4 v[88:91], v1, s[28:31], s49 offen offset:2048 sc1
    buffer_load_dwordx4 v[92:95], v1, s[28:31], s49 offen offset:3072 sc1
    s_add_u32 s49, s49, 4096
    buffer_load_dwordx4 v[96:99], v1, s[28:31], s49 offen offset:0 sc1
    buffer_load_dwordx4 v[100:103], v1, s[28:31], s49 offen offset:1024 sc1
    buffer_load_dwordx4 v[104:107], v1, s[28:31], s49 offen offset:2048 sc1
    buffer_load_dwordx4 v[108:111], v1, s[28:31], s49 offen offset:3072 sc1
    s_add_u32 s49, s49, 4096
    buffer_load_dwordx4 v[112:115], v1, s[28:31], s49 offen offset:0 sc1
    buffer_load_dwordx4 v[116:119], v1, s[28:31], s49 offen offset:1024 sc1
    s_waitcnt lgkmcnt(8)
    v_pk_add_f32 v[16:17], v[16:17], v[32:33]
    v_pk_add_f32 v[18:19], v[18:19], v[34:35]
    v_pk_add_f32 v[20:21], v[20:21], v[36:37]
    v_pk_add_f32 v[22:23], v[22:23], v[38:39]
    v_pk_add_f32 v[24:25], v[24:25], v[40:41]
    v_pk_add_f32 v[26:27], v[26:27], v[42:43]
    v_pk_add_f32 v[28:29], v[28:29], v[44:45]
    v_pk_add_f32 v[30:31], v[30:31], v[46:47]
    v_pk_mul_f32 v[16:17], v[16:17], v[8:9] op_sel:[0,1] op_sel_hi:[1,1]
    v_pk_mul_f32 v[18:19], v[18:19], v[8:9] op_sel:[0,1] op_sel_hi:[1,1]
    v_pk_mul_f32 v[20:21], v[20:21], v[8:9] op_sel:[0,1] op_sel_hi:[1,1]
    v_pk_mul_f32 v[22:23], v[22:23], v[8:9] op_sel:[0,1] op_sel_hi:[1,1]
    v_pk_mul_f32 v[24:25], v[24:25], v[8:9] op_sel:[0,1] op_sel_hi:[1,1]
    v_pk_mul_f32 v[26:27], v[26:27], v[8:9] op_sel:[0,1] op_sel_hi:[1,1]
    v_pk_mul_f32 v[28:29], v[28:29], v[8:9] op_sel:[0,1] op_sel_hi:[1,1]
    v_pk_mul_f32 v[30:31], v[30:31], v[8:9] op_sel:[0,1] op_sel_hi:[1,1]
    s_waitcnt lgkmcnt(4)
    v_pk_add_f32 v[48:49], v[48:49], v[64:65]
    v_pk_add_f32 v[50:51], v[50:51], v[66:67]
    v_pk_add_f32 v[52:53], v[52:53], v[68:69]
    v_pk_add_f32 v[54:55], v[54:55], v[70:71]
    v_pk_add_f32 v[56:57], v[56:57], v[72:73]
    v_pk_add_f32 v[58:59], v[58:59], v[74:75]
    v_pk_add_f32 v[60:61], v[60:61], v[76:77]
    v_pk_add_f32 v[62:63], v[62:63], v[78:79]
    v_pk_mul_f32 v[48:49], v[48:49], v[8:9] op_sel:[0,1] op_sel_hi:[1,1]
    v_pk_mul_f32 v[50:51], v[50:51], v[8:9] op_sel:[0,1] op_sel_hi:[1,1]
    v_pk_mul_f32 v[52:53], v[52:53], v[8:9] op_sel:[0,1] op_sel_hi:[1,1]
    v_pk_mul_f32 v[54:55], v[54:55], v[8:9] op_sel:[0,1] op_sel_hi:[1,1]
    v_pk_mul_f32 v[56:57], v[56:57], v[8:9] op_sel:[0,1] op_sel_hi:[1,1]
    v_pk_mul_f32 v[58:59], v[58:59], v[8:9] op_sel:[0,1] op_sel_hi:[1,1]
    v_pk_mul_f32 v[60:61], v[60:61], v[8:9] op_sel:[0,1] op_sel_hi:[1,1]
    v_pk_mul_f32 v[62:63], v[62:63], v[8:9] op_sel:[0,1] op_sel_hi:[1,1]
    ds_read_b64_tr_b16 v[156:157], v12 offset:2048
    ds_read_b64_tr_b16 v[158:159], v12 offset:3072
    ds_read_b64_tr_b16 v[152:153], v11 offset:2048
    ds_read_b64_tr_b16 v[154:155], v11 offset:3072
    s_waitcnt vmcnt(9) lgkmcnt(4)
    v_mfma_f32_32x32x16_bf16 v[64:79], v[148:151], v[80:83], 0
    ds_read_b64_tr_b16 v[164:165], v12 offset:4096
    ds_read_b64_tr_b16 v[166:167], v12 offset:5120
    buffer_load_dwordx4 v[120:123], v1, s[28:31], s49 offen offset:2048 sc1
    v_mfma_f32_32x32x16_bf16 v[32:47], v[144:147], v[80:83], 0
    ds_read_b64_tr_b16 v[160:161], v11 offset:4096
    ds_read_b64_tr_b16 v[162:163], v11 offset:5120
    buffer_load_dwordx4 v[124:127], v1, s[28:31], s49 offen offset:3072 sc1
    s_add_u32 s49, s49, 4096
    s_waitcnt vmcnt(10) lgkmcnt(4)
    v_mfma_f32_32x32x16_bf16 v[64:79], v[156:159], v[84:87], v[64:79]
    ds_read_b64_tr_b16 v[148:149], v12 offset:6144
    ds_read_b64_tr_b16 v[150:151], v12 offset:7168
    buffer_load_dwordx4 v[128:131], v1, s[28:31], s49 offen offset:0 sc1
    v_mfma_f32_32x32x16_bf16 v[32:47], v[152:155], v[84:87], v[32:47]
    ds_read_b64_tr_b16 v[144:145], v11 offset:6144
    ds_read_b64_tr_b16 v[146:147], v11 offset:7168
    buffer_load_dwordx4 v[132:135], v1, s[28:31], s49 offen offset:1024 sc1
    s_waitcnt vmcnt(11) lgkmcnt(4)
    v_mfma_f32_32x32x16_bf16 v[64:79], v[164:167], v[88:91], v[64:79]
    ds_read_b64_tr_b16 v[156:157], v12 offset:8192
    ds_read_b64_tr_b16 v[158:159], v12 offset:9216
    buffer_load_dwordx4 v[136:139], v1, s[28:31], s49 offen offset:2048 sc1
    v_mfma_f32_32x32x16_bf16 v[32:47], v[160:163], v[88:91], v[32:47]
    ds_read_b64_tr_b16 v[152:153], v11 offset:8192
    ds_read_b64_tr_b16 v[154:155], v11 offset:9216
    buffer_load_dwordx4 v[140:143], v1, s[28:31], s49 offen offset:3072 sc1
    s_waitcnt vmcnt(12) lgkmcnt(4)
    v_mfma_f32_32x32x16_bf16 v[64:79], v[148:151], v[92:95], v[64:79]
    ds_read_b64_tr_b16 v[164:165], v12 offset:10240
    ds_read_b64_tr_b16 v[166:167], v12 offset:11264
    v_mfma_f32_32x32x16_bf16 v[32:47], v[144:147], v[92:95], v[32:47]
    ds_read_b64_tr_b16 v[160:161], v11 offset:10240
    ds_read_b64_tr_b16 v[162:163], v11 offset:11264
    s_waitcnt vmcnt(11) lgkmcnt(4)
    v_mfma_f32_32x32x16_bf16 v[64:79], v[156:159], v[96:99], v[64:79]
    ds_read_b64_tr_b16 v[148:149], v12 offset:12288
    ds_read_b64_tr_b16 v[150:151], v12 offset:13312
    v_mfma_f32_32x32x16_bf16 v[32:47], v[152:155], v[96:99], v[32:47]
    ds_read_b64_tr_b16 v[144:145], v11 offset:12288
    ds_read_b64_tr_b16 v[146:147], v11 offset:13312
    s_waitcnt vmcnt(10) lgkmcnt(4)
    v_mfma_f32_32x32x16_bf16 v[64:79], v[164:167], v[100:103], v[64:79]
    ds_read_b64_tr_b16 v[156:157], v12 offset:14336
    ds_read_b64_tr_b16 v[158:159], v12 offset:15360
    v_mfma_f32_32x32x16_bf16 v[32:47], v[160:163], v[100:103], v[32:47]
    ds_read_b64_tr_b16 v[152:153], v11 offset:14336
    ds_read_b64_tr_b16 v[154:155], v11 offset:15360
    s_waitcnt vmcnt(9) lgkmcnt(4)
    v_mfma_f32_32x32x16_bf16 v[64:79], v[148:151], v[104:107], v[64:79]
    ds_read_b64_tr_b16 v[164:165], v12 offset:16384
    ds_read_b64_tr_b16 v[166:167], v12 offset:17408
    v_mfma_f32_32x32x16_bf16 v[32:47], v[144:147], v[104:107], v[32:47]
    ds_read_b64_tr_b16 v[160:161], v11 offset:16384
    ds_read_b64_tr_b16 v[162:163], v11 offset:17408
    s_waitcnt vmcnt(8) lgkmcnt(4)
    v_mfma_f32_32x32x16_bf16 v[64:79], v[156:159], v[108:111], v[64:79]
    ds_read_b64_tr_b16 v[148:149], v12 offset:18432
    ds_read_b64_tr_b16 v[150:151], v12 offset:19456
    v_mfma_f32_32x32x16_bf16 v[32:47], v[152:155], v[108:111], v[32:47]
    ds_read_b64_tr_b16 v[144:145], v11 offset:18432
    ds_read_b64_tr_b16 v[146:147], v11 offset:19456
    s_waitcnt vmcnt(7) lgkmcnt(4)
    v_mfma_f32_32x32x16_bf16 v[64:79], v[164:167], v[112:115], v[64:79]
    ds_read_b64_tr_b16 v[156:157], v12 offset:20480
    ds_read_b64_tr_b16 v[158:159], v12 offset:21504
    v_mfma_f32_32x32x16_bf16 v[32:47], v[160:163], v[112:115], v[32:47]
    ds_read_b64_tr_b16 v[152:153], v11 offset:20480
    ds_read_b64_tr_b16 v[154:155], v11 offset:21504
    s_waitcnt vmcnt(6) lgkmcnt(4)
    v_mfma_f32_32x32x16_bf16 v[64:79], v[148:151], v[116:119], v[64:79]
    ds_read_b64_tr_b16 v[164:165], v12 offset:22528
    ds_read_b64_tr_b16 v[166:167], v12 offset:23552
    v_mfma_f32_32x32x16_bf16 v[32:47], v[144:147], v[116:119], v[32:47]
    ds_read_b64_tr_b16 v[160:161], v11 offset:22528
    ds_read_b64_tr_b16 v[162:163], v11 offset:23552
    s_waitcnt vmcnt(5) lgkmcnt(4)
    v_mfma_f32_32x32x16_bf16 v[64:79], v[156:159], v[120:123], v[64:79]
    ds_read_b64_tr_b16 v[148:149], v12 offset:24576
    ds_read_b64_tr_b16 v[150:151], v12 offset:25600
    v_mfma_f32_32x32x16_bf16 v[32:47], v[152:155], v[120:123], v[32:47]
    ds_read_b64_tr_b16 v[144:145], v11 offset:24576
    ds_read_b64_tr_b16 v[146:147], v11 offset:25600
    s_waitcnt vmcnt(4) lgkmcnt(4)
    v_mfma_f32_32x32x16_bf16 v[64:79], v[164:167], v[124:127], v[64:79]
    ds_read_b64_tr_b16 v[156:157], v12 offset:26624
    ds_read_b64_tr_b16 v[158:159], v12 offset:27648
    v_mfma_f32_32x32x16_bf16 v[32:47], v[160:163], v[124:127], v[32:47]
    ds_read_b64_tr_b16 v[152:153], v11 offset:26624
    ds_read_b64_tr_b16 v[154:155], v11 offset:27648
    s_waitcnt vmcnt(3) lgkmcnt(4)
    v_mfma_f32_32x32x16_bf16 v[64:79], v[148:151], v[128:131], v[64:79]
    ds_read_b64_tr_b16 v[164:165], v12 offset:28672
    ds_read_b64_tr_b16 v[166:167], v12 offset:29696
    v_mfma_f32_32x32x16_bf16 v[32:47], v[144:147], v[128:131], v[32:47]
    ds_read_b64_tr_b16 v[160:161], v11 offset:28672
    ds_read_b64_tr_b16 v[162:163], v11 offset:29696
    s_waitcnt vmcnt(2) lgkmcnt(4)
    v_mfma_f32_32x32x16_bf16 v[64:79], v[156:159], v[132:135], v[64:79]
    ds_read_b64_tr_b16 v[148:149], v12 offset:30720
    ds_read_b64_tr_b16 v[150:151], v12 offset:31744
    v_mfma_f32_32x32x16_bf16 v[32:47], v[152:155], v[132:135], v[32:47]
    ds_read_b64_tr_b16 v[144:145], v11 offset:30720
    ds_read_b64_tr_b16 v[146:147], v11 offset:31744
    s_waitcnt vmcnt(1) lgkmcnt(4)
    v_mfma_f32_32x32x16_bf16 v[64:79], v[164:167], v[136:139], v[64:79]
    v_mfma_f32_32x32x16_bf16 v[32:47], v[160:163], v[136:139], v[32:47]
    s_waitcnt vmcnt(0) lgkmcnt(0)
    v_mfma_f32_32x32x16_bf16 v[64:79], v[148:151], v[140:143], v[64:79]
    v_mfma_f32_32x32x16_bf16 v[32:47], v[144:147], v[140:143], v[32:47]
    s_nop 10
    v_pk_fma_f32 v[48:49], v[64:65], v[8:9], v[48:49] op_sel_hi:[1,0,1]
    v_pk_fma_f32 v[50:51], v[66:67], v[8:9], v[50:51] op_sel_hi:[1,0,1]
    ds_write_b128 v4, v[48:51] offset:32768
    v_pk_fma_f32 v[52:53], v[68:69], v[8:9], v[52:53] op_sel_hi:[1,0,1]
    v_pk_fma_f32 v[54:55], v[70:71], v[8:9], v[54:55] op_sel_hi:[1,0,1]
    ds_write_b128 v4, v[52:55] offset:33792
    v_pk_fma_f32 v[56:57], v[72:73], v[8:9], v[56:57] op_sel_hi:[1,0,1]
    v_pk_fma_f32 v[58:59], v[74:75], v[8:9], v[58:59] op_sel_hi:[1,0,1]
    ds_write_b128 v4, v[56:59] offset:34816
    v_pk_fma_f32 v[60:61], v[76:77], v[8:9], v[60:61] op_sel_hi:[1,0,1]
    v_pk_fma_f32 v[62:63], v[78:79], v[8:9], v[62:63] op_sel_hi:[1,0,1]
    ds_write_b128 v4, v[60:63] offset:35840
    v_pk_fma_f32 v[16:17], v[32:33], v[8:9], v[16:17] op_sel_hi:[1,0,1]
    v_pk_fma_f32 v[18:19], v[34:35], v[8:9], v[18:19] op_sel_hi:[1,0,1]
    v_pk_fma_f32 v[20:21], v[36:37], v[8:9], v[20:21] op_sel_hi:[1,0,1]
    v_pk_fma_f32 v[22:23], v[38:39], v[8:9], v[22:23] op_sel_hi:[1,0,1]
    v_pk_fma_f32 v[24:25], v[40:41], v[8:9], v[24:25] op_sel_hi:[1,0,1]
    v_pk_fma_f32 v[26:27], v[42:43], v[8:9], v[26:27] op_sel_hi:[1,0,1]
    v_pk_fma_f32 v[28:29], v[44:45], v[8:9], v[28:29] op_sel_hi:[1,0,1]
    v_pk_fma_f32 v[30:31], v[46:47], v[8:9], v[30:31] op_sel_hi:[1,0,1]
    s_waitcnt lgkmcnt(0)
    s_barrier
    ds_read_b128 v[64:67], v7 offset:32768
    ds_read_b128 v[68:71], v7 offset:33792
    ds_read_b128 v[72:75], v7 offset:34816
    ds_read_b128 v[76:79], v7 offset:35840
    s_waitcnt lgkmcnt(2)
    v_pk_add_f32 v[16:17], v[16:17], v[64:65]
    v_pk_add_f32 v[18:19], v[18:19], v[66:67]
    v_pk_add_f32 v[20:21], v[20:21], v[68:69]
    v_pk_add_f32 v[22:23], v[22:23], v[70:71]
    v_cvt_pk_bf16_f32 v32, v16, v17
    v_cvt_pk_bf16_f32 v33, v18, v19
    v_cvt_pk_bf16_f32 v34, v20, v21
    v_cvt_pk_bf16_f32 v35, v22, v23
    s_nop 1
    v_permlane32_swap_b32 v32, v34
    v_permlane32_swap_b32 v33, v35
    s_nop 1
    buffer_store_dwordx4 v[32:35], v10, s[36:39], s50 offen offset:0
    s_waitcnt lgkmcnt(0)
    v_pk_add_f32 v[24:25], v[24:25], v[72:73]
    v_pk_add_f32 v[26:27], v[26:27], v[74:75]
    v_pk_add_f32 v[28:29], v[28:29], v[76:77]
    v_pk_add_f32 v[30:31], v[30:31], v[78:79]
    v_cvt_pk_bf16_f32 v36, v24, v25
    v_cvt_pk_bf16_f32 v37, v26, v27
    v_cvt_pk_bf16_f32 v38, v28, v29
    v_cvt_pk_bf16_f32 v39, v30, v31
    s_nop 1
    v_permlane32_swap_b32 v36, v38
    v_permlane32_swap_b32 v37, v39
    s_nop 1
    buffer_store_dwordx4 v[36:39], v10, s[36:39], s50 offen offset:32
    s_endpgm
L_code_end:
L_at_fallback:
    s_lshl_b32 s46, s48, 16
    s_add_u32 s51, s46, 2097152
    v_mov_b32 v4, 0xff800000
    s_mov_b32 s50, 0
L_at_fb1:
    buffer_load_dwordx4 v[28:31], v1, s[28:31], s51 offen sc1
    s_add_u32 s51, s51, 1024
    s_waitcnt vmcnt(0)
    v_mfma_f32_32x32x16_bf16 v[44:59], v[28:31], v[20:23], 0
    s_nop 15
    v_max3_f32 v4, v4, v44, v45
    v_max3_f32 v4, v4, v46, v47
    v_max3_f32 v4, v4, v48, v49
    v_max3_f32 v4, v4, v50, v51
    v_max3_f32 v4, v4, v52, v53
    v_max3_f32 v4, v4, v54, v55
    v_max3_f32 v4, v4, v56, v57
    v_max3_f32 v4, v4, v58, v59
    s_add_u32 s50, s50, 1
    s_cmp_lt_u32 s50, 64
    s_cbranch_scc1 L_at_fb1
    v_mov_b32 v5, v4
    s_nop 1
    v_permlane32_swap_b32 v4, v5
    s_nop 1
    v_max_f32 v4, v4, v5
    v_sub_f32 v112, 0, v4
    v_sub_f32 v113, 0, v4
    v_pk_mov_b32 v[114:115], v[112:113], v[112:113]
    v_pk_mov_b32 v[116:117], v[112:113], v[112:113]
    v_pk_mov_b32 v[118:119], v[112:113], v[112:113]
    v_pk_mov_b32 v[120:121], v[112:113], v[112:113]
    v_pk_mov_b32 v[122:123], v[112:113], v[112:113]
    v_pk_mov_b32 v[124:125], v[112:113], v[112:113]
    v_pk_mov_b32 v[126:127], v[112:113], v[112:113]
    v_mov_b32 v80, 0
    v_mov_b32 v81, 0
    v_mov_b32 v82, 0
    v_mov_b32 v83, 0
    v_mov_b32 v84, 0
    v_mov_b32 v85, 0
    v_mov_b32 v86, 0
    v_mov_b32 v87, 0
    v_mov_b32 v88, 0
    v_mov_b32 v89, 0
    v_mov_b32 v90, 0
    v_mov_b32 v91, 0
    v_mov_b32 v92, 0
    v_mov_b32 v93, 0
    v_mov_b32 v94, 0
    v_mov_b32 v95, 0
    v_and_b32 v4, 15, v0
    v_lshlrev_b32 v4, 4, v4
    v_lshrrev_b32 v5, 5, v0
    v_lshl_add_u32 v9, v5, 8, v4
    s_add_u32 s51, s46, 2097152
    s_add_u32 s52, s46, 4194304
    s_mov_b32 s50, 0
    s_mov_b32 s44, 0xffff
    s_mov_b32 s45, 0xffff
L_at_fb2:
    buffer_load_dwordx4 v[28:31], v77, s[28:31], s51 offen sc1
    s_mov_b64 exec, s[44:45]
    buffer_load_dwordx4 v[32:35], v9, s[28:31], s52 offen sc1
    buffer_load_dwordx4 v[36:39], v9, s[28:31], s52 offen offset:512 sc1
    s_mov_b64 exec, -1
    s_add_u32 s51, s51, 1024
    s_add_u32 s52, s52, 1024
    s_waitcnt vmcnt(0)
    v_mfma_f32_32x32x16_bf16 v[44:59], v[28:31], v[20:23], v[112:127]
    s_nop 15
    v_exp_f32 v44, v44
    v_exp_f32 v45, v45
    v_exp_f32 v46, v46
    v_exp_f32 v47, v47
    v_exp_f32 v48, v48
    v_exp_f32 v49, v49
    v_exp_f32 v50, v50
    v_exp_f32 v51, v51
    v_exp_f32 v52, v52
    v_exp_f32 v53, v53
    v_exp_f32 v54, v54
    v_exp_f32 v55, v55
    v_exp_f32 v56, v56
    v_exp_f32 v57, v57
    v_exp_f32 v58, v58
    v_exp_f32 v59, v59
    s_nop 2
    v_smfmac_f32_32x32x32_bf16 v[80:95], v[32:35], v[44:51], v76
    v_smfmac_f32_32x32x32_bf16 v[80:95], v[36:39], v[52:59], v76
    s_nop 15
    s_add_u32 s50, s50, 1
    s_cmp_lt_u32 s50, 64
    s_cbranch_scc1 L_at_fb2
    v_rcp_f32 v4, v88
    s_branch L_at_fin
L_exit:
    s_endpgm
.section .rodata,"a"
.p2align 6
.amdhsa_kernel gated_mix__mha_block__glu_gated_glu__prompt_kernel
  .amdhsa_next_free_vgpr 168
  .amdhsa_next_free_sgpr 102
  .amdhsa_accum_offset 168
  .amdhsa_group_segment_fixed_size 0
  .amdhsa_kernarg_size 88
  .amdhsa_user_sgpr_count 2
  .amdhsa_user_sgpr_kernarg_segment_ptr 1
  .amdhsa_system_sgpr_workgroup_id_x 1
.end_amdhsa_kernel
```
